```python
import torch

def _softmax(x, axis=-1):
    return torch.softmax(x, dim=axis)

def _gelu(x):
    return torch.nn.functional.gelu(x, approximate='tanh')

def _silu(x):
    return torch.nn.functional.silu(x)

def _sigmoid(x):
    return torch.sigmoid(x)

def _layernorm(x, axis=-1, eps=1e-05):
    m = x.mean(dim=axis, keepdim=True)
    v = x.var(dim=axis, keepdim=True, unbiased=False)
    return (x - m) / torch.sqrt(v + eps)

def _scatter_add(tgt, idx, src, axis=0):
    return tgt.clone().index_add_(axis, idx, src)

def _segment_sum(src, seg, n):
    out = torch.zeros((n,) + src.shape[1:], dtype=src.dtype)
    return out.index_add_(0, seg, src)

def _pad(x, pw):
    flat = tuple((v for pair in reversed(pw) for v in pair))
    return torch.nn.functional.pad(x, flat)
kernel_name = 'standalone__window_attn_cswin__vision'

def setup_inputs():

    _w = lambda a: (lambda t: t.to(torch.bfloat16) if t.is_floating_point() else t)(torch.as_tensor(a))
    sw = 8
    H = W = 224 // sw * sw
    C = 96 // 2 * 2
    return {'x': _w((lambda *s: torch.randn(*s, dtype=torch.bfloat16) * 0.4)(1, H, W, C)), 'wqkv': _w((lambda *s: torch.randn(*s, dtype=torch.bfloat16) * 0.4)(C, 3 * C)), 'wo': _w((lambda *s: torch.randn(*s, dtype=torch.bfloat16) * 0.05)(C, C))}

def reference(x, wqkv, wo):
    B, H, W, C = x.shape
    sw = 8
    C2 = C // 2
    nh, nw = (H // sw, W // sw)
    qkv = torch.einsum('bhwc,cd->bhwd', x, wqkv)
    q, k, v = (qkv[..., :C].clone(), qkv[..., C:2 * C].clone(), qkv[..., 2 * C:].clone())
    scale = C2 ** (-0.5)
    qh = q[..., :C2].reshape(B * nh, sw * W, C2)
    kh = k[..., :C2].reshape(B * nh, sw * W, C2)
    vh = v[..., :C2].reshape(B * nh, sw * W, C2)
    ah = _softmax(torch.einsum('bqc,bkc->bqk', qh, kh) * scale, axis=-1)
    oh = torch.einsum('bqk,bkc->bqc', ah, vh).reshape(B, H, W, C2)
    qv = (lambda x, *d: x.permute(*d))(q[..., C2:].reshape(B, H, nw, sw, C2), 0, 2, 1, 3, 4).reshape(B * nw, H * sw, C2)
    kv = (lambda x, *d: x.permute(*d))(k[..., C2:].reshape(B, H, nw, sw, C2), 0, 2, 1, 3, 4).reshape(B * nw, H * sw, C2)
    vv = (lambda x, *d: x.permute(*d))(v[..., C2:].reshape(B, H, nw, sw, C2), 0, 2, 1, 3, 4).reshape(B * nw, H * sw, C2)
    av = _softmax(torch.einsum('bqc,bkc->bqk', qv, kv) * scale, axis=-1)
    ov = torch.einsum('bqk,bkc->bqc', av, vv).reshape(B, nw, H, sw, C2)
    ov = (lambda x, *d: x.permute(*d))(ov, 0, 2, 1, 3, 4).reshape(B, H, W, C2)
    o = _pad(oh, ((0, 0), (0, 0), (0, 0), (0, C2))) + _pad(ov, ((0, 0), (0, 0), (0, 0), (C2, 0)))
    return torch.einsum('bhwc,cd->bhwd', o, wo)
```

```asm
; @launch grid=(224,1,1) block=(512,1,1) lds=163840
.amdgcn_target "amdgcn-amd-amdhsa--gfx950"
.text
.globl standalone__window_attn_cswin__vision_kernel
.p2align 8
.type standalone__window_attn_cswin__vision_kernel,@function
standalone__window_attn_cswin__vision_kernel:
    s_cmp_ge_u32 s2, 224
    s_cbranch_scc1 L_end
    s_load_dwordx4 s[4:7], s[0:1], 0
    s_load_dwordx4 s[8:11], s[0:1], 32
    s_load_dwordx4 s[84:87], s[0:1], 16
    v_and_b32 v247, 63, v0
    v_lshrrev_b32 v248, 6, v0
    v_lshlrev_b32 v254, 4, v247
    v_readfirstlane_b32 s26, v248
    s_and_b32 s34, s2, 7
    s_lshr_b32 s35, s2, 3
    s_mul_i32 s24, s34, 7
    s_and_b32 s25, s35, 3
    s_lshr_b32 s35, s35, 2
    s_add_u32 s24, s24, s35
    s_mul_i32 s28, s25, 14
    s_cmp_ge_u32 s24, 28
    s_cselect_b32 s27, 1, 0
    s_cmp_ge_u32 s26, 4
    s_cselect_b32 s29, 1, 0
    s_mul_i32 s48, s26, 3
    s_mov_b32 s30, 0
    s_sub_u32 s49, s26, 4
    s_cmp_eq_u32 s29, 0
    s_cbranch_scc1 L_roleA
    s_and_b32 s30, s49, 1
    s_lshr_b32 s34, s49, 1
    s_add_u32 s48, s34, 12
L_roleA:
    s_add_u32 s98, s48, s27
    s_and_b32 s98, s98, 1
    s_mov_b32 s38, 51200
    s_mov_b32 s39, 4294864896
    s_mul_i32 s40, s24, 344064
    v_lshlrev_b32 v248, 2, v247
    v_mov_b32 v249, 0
    v_add_u32 v248, 153600, v248
    ds_write_b32 v248, v249
    s_cmp_eq_u32 s29, 1
    s_cbranch_scc0 L_nopf
    s_getpc_b64 s[90:91]
L_pfpc:
    s_sub_u32 s90, s90, L_pfpc-standalone__window_attn_cswin__vision_kernel
    s_subb_u32 s91, s91, 0
    v_lshlrev_b32 v248, 6, v247
    s_lshl_b32 s34, s49, 12
    v_add_u32 v248, s34, v248
    v_min_u32 v249, L_end-standalone__window_attn_cswin__vision_kernel, v248
    global_load_dword v232, v249, s[90:91]
    v_add_u32 v248, 16384, v248
    v_min_u32 v249, L_end-standalone__window_attn_cswin__vision_kernel, v248
    global_load_dword v232, v249, s[90:91]
L_nopf:
    s_getreg_b32 s42, hwreg(HW_REG_XCC_ID)
    s_and_b32 s42, s42, 15
    s_cmp_eq_u32 s29, 1
    s_cbranch_scc0 L_noxg
    v_add_u32 v248, 0, v247
    v_mul_u32_u24 v249, 5462, v248
    v_lshrrev_b32 v249, 16, v249
    v_mul_u32_u24 v250, 12, v249
    v_sub_u32 v250, v248, v250
    v_bfe_u32 v251, v249, 2, 2
    v_xor_b32 v250, v250, v251
    v_lshrrev_b32 v251, 3, v249
    v_mul_u32_u24 v251, 224, v251
    v_and_b32 v249, 7, v249
    v_add_u32 v249, v249, v251
    v_mul_u32_u24 v249, 192, v249
    v_lshl_add_u32 v204, v250, 4, v249
    v_add_u32 v248, 64, v247
    v_mul_u32_u24 v249, 5462, v248
    v_lshrrev_b32 v249, 16, v249
    v_mul_u32_u24 v250, 12, v249
    v_sub_u32 v250, v248, v250
    v_bfe_u32 v251, v249, 2, 2
    v_xor_b32 v250, v250, v251
    v_lshrrev_b32 v251, 3, v249
    v_mul_u32_u24 v251, 224, v251
    v_and_b32 v249, 7, v249
    v_add_u32 v249, v249, v251
    v_mul_u32_u24 v249, 192, v249
    v_lshl_add_u32 v205, v250, 4, v249
    v_add_u32 v248, 128, v247
    v_mul_u32_u24 v249, 5462, v248
    v_lshrrev_b32 v249, 16, v249
    v_mul_u32_u24 v250, 12, v249
    v_sub_u32 v250, v248, v250
    v_bfe_u32 v251, v249, 2, 2
    v_xor_b32 v250, v250, v251
    v_lshrrev_b32 v251, 3, v249
    v_mul_u32_u24 v251, 224, v251
    v_and_b32 v249, 7, v249
    v_add_u32 v249, v249, v251
    v_mul_u32_u24 v249, 192, v249
    v_lshl_add_u32 v206, v250, 4, v249
    v_add_u32 v248, 192, v247
    v_mul_u32_u24 v249, 5462, v248
    v_lshrrev_b32 v249, 16, v249
    v_mul_u32_u24 v250, 12, v249
    v_sub_u32 v250, v248, v250
    v_bfe_u32 v251, v249, 2, 2
    v_xor_b32 v250, v250, v251
    v_lshrrev_b32 v251, 3, v249
    v_mul_u32_u24 v251, 224, v251
    v_and_b32 v249, 7, v249
    v_add_u32 v249, v249, v251
    v_mul_u32_u24 v249, 192, v249
    v_lshl_add_u32 v207, v250, 4, v249
    v_add_u32 v248, 256, v247
    v_mul_u32_u24 v249, 5462, v248
    v_lshrrev_b32 v249, 16, v249
    v_mul_u32_u24 v250, 12, v249
    v_sub_u32 v250, v248, v250
    v_bfe_u32 v251, v249, 2, 2
    v_xor_b32 v250, v250, v251
    v_lshrrev_b32 v251, 3, v249
    v_mul_u32_u24 v251, 224, v251
    v_and_b32 v249, 7, v249
    v_add_u32 v249, v249, v251
    v_mul_u32_u24 v249, 192, v249
    v_lshl_add_u32 v208, v250, 4, v249
    v_add_u32 v248, 320, v247
    v_mul_u32_u24 v249, 5462, v248
    v_lshrrev_b32 v249, 16, v249
    v_mul_u32_u24 v250, 12, v249
    v_sub_u32 v250, v248, v250
    v_bfe_u32 v251, v249, 2, 2
    v_xor_b32 v250, v250, v251
    v_lshrrev_b32 v251, 3, v249
    v_mul_u32_u24 v251, 224, v251
    v_and_b32 v249, 7, v249
    v_add_u32 v249, v249, v251
    v_mul_u32_u24 v249, 192, v249
    v_lshl_add_u32 v209, v250, 4, v249
    v_lshlrev_b32 v248, 2, v247
    v_add_u32 v248, 153856, v248
    ds_write_b32 v248, v204 offset:0
    ds_write_b32 v248, v205 offset:256
    ds_write_b32 v248, v206 offset:512
    ds_write_b32 v248, v207 offset:768
    ds_write_b32 v248, v208 offset:1024
    ds_write_b32 v248, v209 offset:1280
L_noxg:
    s_waitcnt lgkmcnt(0)
    s_barrier
    s_mov_b32 s68, s8
    s_mov_b32 s69, s9
    s_mov_b32 s12, s4
    s_and_b32 s13, s5, 0xffff
    s_mov_b32 s14, 9633792
    s_mov_b32 s15, 0x20000
    s_mov_b32 s16, s6
    s_and_b32 s17, s7, 0xffff
    s_mov_b32 s18, 55296
    s_mov_b32 s19, 0x20000
    s_mov_b32 s20, s10
    s_and_b32 s21, s11, 0xffff
    s_mov_b32 s22, 25948288
    s_mov_b32 s23, 0x20000
    s_mov_b32 s76, s84
    s_and_b32 s77, s85, 0xffff
    s_mov_b32 s78, 18432
    s_mov_b32 s79, 0x20000
    s_mov_b32 s80, s86
    s_and_b32 s81, s87, 0xffff
    s_mov_b32 s82, 9633792
    s_mov_b32 s83, 0x20000
    s_cmp_eq_u32 s26, 5
    s_cbranch_scc0 L_noreg
    s_mul_i32 s34, s42, s42
    s_lshl_b32 s34, s34, 16
    s_lshl_b32 s35, s42, 8
    s_add_u32 s34, s34, s35
    s_add_u32 s34, s34, 1
    s_lshl_b32 s35, s24, 2
    s_add_u32 s35, s35, 32
    v_mov_b32 v248, s35
    v_mov_b32 v249, s34
    s_mov_b64 exec, 1
    global_atomic_add v248, v249, s[68:69] sc1
    s_mov_b64 exec, -1
L_noreg:
    s_cmp_eq_u32 s29, 1
    s_cbranch_scc0 L_nox0
    s_mul_i32 s100, s49, 3
    s_mov_b32 s41, s100
    s_add_u32 s34, s28, s41
    s_lshr_b32 s35, s34, 1
    s_and_b32 s36, s34, 1
    s_lshl_b32 s37, s24, 1
    s_add_u32 s36, s36, s37
    s_sub_u32 s37, s24, 28
    s_cmp_eq_u32 s27, 1
    s_cselect_b32 s35, s37, s35
    s_cselect_b32 s36, s34, s36
    s_mul_i32 s36, s36, 896
    s_lshl_b32 s35, s35, 3
    s_add_u32 s36, s36, s35
    s_mul_i32 s36, s36, 192
    s_mul_i32 m0, s41, 6400
    s_nop 0
    buffer_load_dwordx4 v204, s[12:15], s36 offen nt lds
    s_add_u32 m0, m0, 1024
    s_nop 0
    buffer_load_dwordx4 v205, s[12:15], s36 offen nt lds
    s_add_u32 m0, m0, 1024
    s_nop 0
    buffer_load_dwordx4 v206, s[12:15], s36 offen nt lds
    s_add_u32 m0, m0, 1024
    s_nop 0
    buffer_load_dwordx4 v207, s[12:15], s36 offen nt lds
    s_add_u32 m0, m0, 1024
    s_nop 0
    buffer_load_dwordx4 v208, s[12:15], s36 offen nt lds
    s_add_u32 m0, m0, 1024
    s_nop 0
    buffer_load_dwordx4 v209, s[12:15], s36 offen nt lds
L_nox0:
    s_mul_i32 s44, s27, 96
    s_mov_b32 s45, s26
L_wloop:
    s_lshl_b32 s35, s45, 6
    v_add_u32 v248, s35, v247
    v_mul_u32_u24 v249, 3277, v248
    v_lshrrev_b32 v249, 16, v249
    v_mul_u32_u24 v250, 20, v249
    v_sub_u32 v250, v248, v250
    v_mul_u32_u24 v251, 43, v250
    v_lshrrev_b32 v251, 8, v251
    v_mul_u32_u24 v251, 96, v251
    v_lshlrev_b32 v250, 4, v250
    v_mul_u32_u24 v249, 576, v249
    v_add3_u32 v249, v249, v250, v251
    s_lshl_b32 s35, s45, 10
    s_add_u32 m0, s35, 89600
    s_nop 0
    buffer_load_dwordx4 v249, s[16:19], s44 offen lds
    s_add_u32 s45, s45, 8
    s_cmp_lt_u32 s45, 30
    s_cbranch_scc1 L_wloop
    s_cmp_eq_u32 s29, 1
    s_cbranch_scc1 L_ldB
    s_cmp_eq_u32 s2, 0
    s_cbranch_scc0 L_non
    s_cmp_eq_u32 s26, 0
    s_cbranch_scc0 L_non
    v_mov_b32 v248, 25718784
    buffer_load_dword v250, v248, s[20:23], 0 offen sc1
    s_waitcnt vmcnt(0)
    v_add_u32 v250, 2, v250
    v_or_b32 v250, 1, v250
    v_mov_b32 v249, 4
    s_mov_b64 exec, 1
    global_store_dword v249, v250, s[68:69] sc1
    buffer_store_dword v250, v248, s[20:23], 0 offen sc1
    s_mov_b64 exec, -1
L_non:
    s_branch L_lddone
L_ldB:
    s_setprio 2
    s_mul_i32 s100, s49, 3
    s_cmp_eq_u32 s30, 1
    s_cbranch_scc1 L_ldB1
    s_add_u32 s41, s100, 1
    s_add_u32 s34, s28, s41
    s_lshr_b32 s35, s34, 1
    s_and_b32 s36, s34, 1
    s_lshl_b32 s37, s24, 1
    s_add_u32 s36, s36, s37
    s_sub_u32 s37, s24, 28
    s_cmp_eq_u32 s27, 1
    s_cselect_b32 s35, s37, s35
    s_cselect_b32 s36, s34, s36
    s_mul_i32 s36, s36, 896
    s_lshl_b32 s35, s35, 3
    s_add_u32 s36, s36, s35
    s_mul_i32 s36, s36, 192
    s_mul_i32 m0, s41, 6400
    s_nop 0
    buffer_load_dwordx4 v204, s[12:15], s36 offen nt lds
    s_add_u32 m0, m0, 1024
    s_nop 0
    buffer_load_dwordx4 v205, s[12:15], s36 offen nt lds
    s_add_u32 m0, m0, 1024
    s_nop 0
    buffer_load_dwordx4 v206, s[12:15], s36 offen nt lds
    s_add_u32 m0, m0, 1024
    s_nop 0
    buffer_load_dwordx4 v207, s[12:15], s36 offen nt lds
    s_add_u32 m0, m0, 1024
    s_nop 0
    buffer_load_dwordx4 v208, s[12:15], s36 offen nt lds
    s_add_u32 m0, m0, 1024
    s_nop 0
    buffer_load_dwordx4 v209, s[12:15], s36 offen nt lds
    s_waitcnt vmcnt(6)
    v_mov_b32 v248, 153632
    v_mov_b32 v249, 1
    s_mov_b64 exec, 1
    ds_add_u32 v248, v249
    s_mov_b64 exec, -1
    s_add_u32 s34, s100, 0
    s_lshl_b32 s34, s34, 2
    s_add_u32 s34, s34, 153664
    v_mov_b32 v248, s34
    v_mov_b32 v249, 1
    ds_write_b32 v248, v249
    s_add_u32 s41, s100, 2
    s_add_u32 s34, s28, s41
    s_lshr_b32 s35, s34, 1
    s_and_b32 s36, s34, 1
    s_lshl_b32 s37, s24, 1
    s_add_u32 s36, s36, s37
    s_sub_u32 s37, s24, 28
    s_cmp_eq_u32 s27, 1
    s_cselect_b32 s35, s37, s35
    s_cselect_b32 s36, s34, s36
    s_mul_i32 s36, s36, 896
    s_lshl_b32 s35, s35, 3
    s_add_u32 s36, s36, s35
    s_mul_i32 s36, s36, 192
    s_mul_i32 m0, s41, 6400
    s_nop 0
    buffer_load_dwordx4 v204, s[12:15], s36 offen nt lds
    s_add_u32 m0, m0, 1024
    s_nop 0
    buffer_load_dwordx4 v205, s[12:15], s36 offen nt lds
    s_add_u32 m0, m0, 1024
    s_nop 0
    buffer_load_dwordx4 v206, s[12:15], s36 offen nt lds
    s_add_u32 m0, m0, 1024
    s_nop 0
    buffer_load_dwordx4 v207, s[12:15], s36 offen nt lds
    s_add_u32 m0, m0, 1024
    s_nop 0
    buffer_load_dwordx4 v208, s[12:15], s36 offen nt lds
    s_add_u32 m0, m0, 1024
    s_nop 0
    buffer_load_dwordx4 v209, s[12:15], s36 offen nt lds
    s_waitcnt vmcnt(6)
    s_add_u32 s34, s100, 1
    s_lshl_b32 s34, s34, 2
    s_add_u32 s34, s34, 153664
    v_mov_b32 v248, s34
    v_mov_b32 v249, 1
    ds_write_b32 v248, v249
    s_mov_b32 s41, s48
    s_add_u32 s34, s28, s41
    s_lshr_b32 s35, s34, 1
    s_and_b32 s36, s34, 1
    s_lshl_b32 s37, s24, 1
    s_add_u32 s36, s36, s37
    s_sub_u32 s37, s24, 28
    s_cmp_eq_u32 s27, 1
    s_cselect_b32 s35, s37, s35
    s_cselect_b32 s36, s34, s36
    s_mul_i32 s36, s36, 896
    s_lshl_b32 s35, s35, 3
    s_add_u32 s36, s36, s35
    s_mul_i32 s36, s36, 192
    s_sub_u32 s35, s41, 12
    s_mul_i32 s35, s35, 6144
    s_add_u32 m0, s35, 120320
    s_nop 0
    buffer_load_dwordx4 v204, s[12:15], s36 offen nt lds
    s_add_u32 m0, m0, 1024
    s_nop 0
    buffer_load_dwordx4 v205, s[12:15], s36 offen nt lds
    s_add_u32 m0, m0, 1024
    s_nop 0
    buffer_load_dwordx4 v206, s[12:15], s36 offen nt lds
    s_add_u32 m0, m0, 1024
    s_nop 0
    buffer_load_dwordx4 v207, s[12:15], s36 offen nt lds
    s_add_u32 m0, m0, 1024
    s_nop 0
    buffer_load_dwordx4 v208, s[12:15], s36 offen nt lds
    s_add_u32 m0, m0, 1024
    s_nop 0
    buffer_load_dwordx4 v209, s[12:15], s36 offen nt lds
    s_waitcnt vmcnt(6)
    s_add_u32 s34, s100, 2
    s_lshl_b32 s34, s34, 2
    s_add_u32 s34, s34, 153664
    v_mov_b32 v248, s34
    v_mov_b32 v249, 1
    ds_write_b32 v248, v249
    s_waitcnt vmcnt(0)
    s_mov_b32 s34, s48
    s_lshl_b32 s34, s34, 2
    s_add_u32 s34, s34, 153664
    v_mov_b32 v248, s34
    v_mov_b32 v249, 1
    ds_write_b32 v248, v249
    s_branch L_lddone
L_ldB1:
    s_add_u32 s41, s100, 1
    s_add_u32 s34, s28, s41
    s_lshr_b32 s35, s34, 1
    s_and_b32 s36, s34, 1
    s_lshl_b32 s37, s24, 1
    s_add_u32 s36, s36, s37
    s_sub_u32 s37, s24, 28
    s_cmp_eq_u32 s27, 1
    s_cselect_b32 s35, s37, s35
    s_cselect_b32 s36, s34, s36
    s_mul_i32 s36, s36, 896
    s_lshl_b32 s35, s35, 3
    s_add_u32 s36, s36, s35
    s_mul_i32 s36, s36, 192
    s_mul_i32 m0, s41, 6400
    s_nop 0
    buffer_load_dwordx4 v204, s[12:15], s36 offen nt lds
    s_add_u32 m0, m0, 1024
    s_nop 0
    buffer_load_dwordx4 v205, s[12:15], s36 offen nt lds
    s_add_u32 m0, m0, 1024
    s_nop 0
    buffer_load_dwordx4 v206, s[12:15], s36 offen nt lds
    s_add_u32 m0, m0, 1024
    s_nop 0
    buffer_load_dwordx4 v207, s[12:15], s36 offen nt lds
    s_add_u32 m0, m0, 1024
    s_nop 0
    buffer_load_dwordx4 v208, s[12:15], s36 offen nt lds
    s_add_u32 m0, m0, 1024
    s_nop 0
    buffer_load_dwordx4 v209, s[12:15], s36 offen nt lds
    s_waitcnt vmcnt(6)
    v_mov_b32 v248, 153632
    v_mov_b32 v249, 1
    s_mov_b64 exec, 1
    ds_add_u32 v248, v249
    s_mov_b64 exec, -1
    s_add_u32 s34, s100, 0
    s_lshl_b32 s34, s34, 2
    s_add_u32 s34, s34, 153664
    v_mov_b32 v248, s34
    v_mov_b32 v249, 1
    ds_write_b32 v248, v249
    s_add_u32 s41, s100, 2
    s_add_u32 s34, s28, s41
    s_lshr_b32 s35, s34, 1
    s_and_b32 s36, s34, 1
    s_lshl_b32 s37, s24, 1
    s_add_u32 s36, s36, s37
    s_sub_u32 s37, s24, 28
    s_cmp_eq_u32 s27, 1
    s_cselect_b32 s35, s37, s35
    s_cselect_b32 s36, s34, s36
    s_mul_i32 s36, s36, 896
    s_lshl_b32 s35, s35, 3
    s_add_u32 s36, s36, s35
    s_mul_i32 s36, s36, 192
    s_mul_i32 m0, s41, 6400
    s_nop 0
    buffer_load_dwordx4 v204, s[12:15], s36 offen nt lds
    s_add_u32 m0, m0, 1024
    s_nop 0
    buffer_load_dwordx4 v205, s[12:15], s36 offen nt lds
    s_add_u32 m0, m0, 1024
    s_nop 0
    buffer_load_dwordx4 v206, s[12:15], s36 offen nt lds
    s_add_u32 m0, m0, 1024
    s_nop 0
    buffer_load_dwordx4 v207, s[12:15], s36 offen nt lds
    s_add_u32 m0, m0, 1024
    s_nop 0
    buffer_load_dwordx4 v208, s[12:15], s36 offen nt lds
    s_add_u32 m0, m0, 1024
    s_nop 0
    buffer_load_dwordx4 v209, s[12:15], s36 offen nt lds
    s_waitcnt vmcnt(6)
    s_add_u32 s34, s100, 1
    s_lshl_b32 s34, s34, 2
    s_add_u32 s34, s34, 153664
    v_mov_b32 v248, s34
    v_mov_b32 v249, 1
    ds_write_b32 v248, v249
    s_waitcnt vmcnt(0)
    s_add_u32 s34, s100, 2
    s_lshl_b32 s34, s34, 2
    s_add_u32 s34, s34, 153664
    v_mov_b32 v248, s34
    v_mov_b32 v249, 1
    ds_write_b32 v248, v249
    v_lshlrev_b32 v248, 16, v247
    v_cmp_gt_u32 vcc, 7, v247
    s_and_saveexec_b64 s[46:47], vcc
    buffer_load_dword v232, v248, s[20:23], s40 offen
    v_lshlrev_b32 v248, 20, v247
    s_mov_b32 s34, 19267584
    buffer_load_dword v233, v248, s[20:23], s34 offen
    v_lshlrev_b32 v248, 21, v247
    buffer_load_dword v234, v248, s[80:83], 0 offen
    s_mov_b64 exec, s[46:47]
L_lddone:
    s_lshl_b32 s34, s26, 2
    v_and_b32 v248, 15, v247
    v_cmp_eq_u32 vcc, 0, v248
    v_mov_b32 v249, 0x3f803f80
    v_lshlrev_b32 v248, 4, v248
    s_nop 0
    v_cndmask_b32 v176, 0, v249, vcc
    v_cndmask_b32 v177, 0, v249, vcc
    v_cndmask_b32 v178, 0, v249, vcc
    v_cndmask_b32 v179, 0, v249, vcc
    v_lshrrev_b32 v249, 4, v247
    v_add_u32 v249, s34, v249
    v_mul_u32_u24 v250, 6400, v249
    v_add_u32 v250, v250, v248
    v_cmp_gt_u32 vcc, 14, v249
    s_and_saveexec_b64 s[46:47], vcc
    s_cbranch_execz L_pad_1
    ds_write_b128 v250, v[176:179] offset:6144
L_pad_1:
    s_mov_b64 exec, s[46:47]
    v_lshrrev_b32 v248, 5, v247
    v_lshlrev_b32 v248, 3, v248
    v_bfe_u32 v249, v247, 2, 2
    v_add_u32 v248, v248, v249
    v_mul_u32_u24 v248, 320, v248
    v_bfe_u32 v249, v247, 4, 1
    v_lshlrev_b32 v249, 5, v249
    v_and_b32 v250, 3, v247
    v_lshlrev_b32 v250, 3, v250
    v_add3_u32 v252, v248, v249, v250
    v_add_u32 v252, 89600, v252
    s_mul_i32 s35, s48, 6400
    s_sub_u32 s34, s48, 12
    s_mul_i32 s34, s34, 6144
    s_add_u32 s34, s34, 120320
    s_cmp_eq_u32 s29, 1
    s_cselect_b32 s34, s34, s35
    v_and_b32 v248, 31, v247
    v_mul_u32_u24 v249, 192, v248
    v_add_u32 v249, s34, v249
    v_bfe_u32 v250, v247, 2, 2
    v_lshrrev_b32 v251, 5, v247
    v_xor_b32 v248, v251, v250
    v_lshl_add_u32 v245, v248, 4, v249
    v_xor_b32 v248, 2, v248
    v_lshl_add_u32 v246, v248, 4, v249
    v_lshrrev_b32 v248, 5, v247
    v_lshlrev_b32 v248, 8, v248
    v_and_b32 v249, 15, v247
    v_lshlrev_b32 v249, 4, v249
    v_add3_u32 v253, v248, v249, s35
    v_and_b32 v248, 0x33, v247
    v_bfe_u32 v249, v247, 2, 1
    v_lshl_or_b32 v248, v249, 3, v248
    v_bfe_u32 v249, v247, 3, 1
    v_lshl_or_b32 v248, v249, 2, v248
    v_lshlrev_b32 v248, 4, v248
    v_add_u32 v236, s35, v248
    v_add_u32 v251, s35, v254
    s_mov_b32 s44, 1045773205
    s_mov_b32 s45, 1045773205
    s_mov_b32 s46, 0x0000ffff
    s_mov_b32 s47, 0x0000ffff
    s_add_u32 s96, s28, s48
    s_mul_i32 s96, s96, 6144
    s_add_u32 s96, s96, s40
    v_subrev_u32 v237, s35, v236
    v_subrev_u32 v238, s35, v253
    s_mov_b32 s99, s35
    v_bfe_u32 v248, v247, 4, 1
    v_lshlrev_b32 v248, 9, v248
    v_add_u32 v235, v248, v238
    v_add_u32 v234, v248, v253
    s_cmp_eq_u32 s29, 1
    s_cbranch_scc1 L_p1B
    v_mov_b32 v240, 0xdddddddd
    s_mul_i32 s34, s30, 6400
    v_add_u32 v241, s34, v254
    v_add_u32 v242, s34, v254
    v_lshrrev_b32 v249, 5, v247
    v_lshlrev_b32 v249, 8, v249
    v_and_b32 v250, 15, v247
    v_lshlrev_b32 v251, 4, v250
    v_add_u32 v249, v249, v251
    v_add_u32 v251, -4, v250
    v_cmp_gt_u32 vcc, 8, v251
    v_mov_b32 v251, 1040
    v_mov_b32 v248, 1088
    v_cndmask_b32 v251, v251, v248, vcc
    v_cmp_eq_u32 vcc, 0, v250
    v_mov_b32 v248, 1024
    s_nop 0
    v_cndmask_b32 v251, v251, v248, vcc
    v_and_b32 v248, 16, v247
    v_cmp_eq_u32 vcc, 0, v248
    v_add_u32 v250, 512, v249
    s_nop 0
    v_cndmask_b32 v243, v251, v249, vcc
    v_cndmask_b32 v244, v251, v250, vcc
    v_add_u32 v243, s34, v243
    v_add_u32 v244, s34, v244
    v_add_u32 v239, s99, v254
    s_waitcnt vmcnt(0) lgkmcnt(0)
    v_mov_b32 v248, 153632
    v_mov_b32 v249, 1
    s_mov_b64 exec, 1
    ds_add_u32 v248, v249
    s_mov_b64 exec, -1
    s_setprio 3
    v_mov_b32 v248, 153632
    s_mov_b32 s37, 0
L_spwA:
    ds_read_b32 v249, v248
    s_waitcnt lgkmcnt(0)
    v_readfirstlane_b32 s34, v249
    s_cmp_eq_u32 s34, 8
    s_cbranch_scc1 L_spdwA
    s_sleep 1
    s_add_u32 s37, s37, 1
    s_cmp_lt_u32 s37, 0x100000
    s_cbranch_scc1 L_spwA
L_spdwA:
    s_add_u32 s35, s48, 0
    s_lshl_b32 s35, s35, 2
    s_add_u32 s35, s35, 153664
    v_mov_b32 v248, s35
    ds_read_b32 v249, v248
    s_waitcnt lgkmcnt(0)
    v_readfirstlane_b32 s34, v249
    s_cmp_eq_u32 s34, 1
    s_cbranch_scc0 L_xslow0
L_xd0:
    ds_read_b128 v[132:135], v245 offset:0
    ds_read_b128 v[136:139], v246 offset:0
    ds_read_b128 v[140:143], v245 offset:64
    ds_read_b128 v[144:147], v246 offset:64
    ds_read_b128 v[148:151], v245 offset:128
    ds_read_b128 v[152:155], v246 offset:128
    ds_read_b64_tr_b16 v[180:181], v252 offset:0
    ds_read_b64_tr_b16 v[182:183], v252 offset:1280
    ds_read_b64_tr_b16 v[184:185], v252 offset:64
    ds_read_b64_tr_b16 v[186:187], v252 offset:1344
    ds_read_b64_tr_b16 v[188:189], v252 offset:128
    ds_read_b64_tr_b16 v[190:191], v252 offset:1408
    ds_read_b64_tr_b16 v[192:193], v252 offset:5120
    ds_read_b64_tr_b16 v[194:195], v252 offset:6400
    ds_read_b64_tr_b16 v[196:197], v252 offset:5184
    ds_read_b64_tr_b16 v[198:199], v252 offset:6464
    ds_read_b64_tr_b16 v[200:201], v252 offset:5248
    ds_read_b64_tr_b16 v[202:203], v252 offset:6528
    ds_read_b64_tr_b16 v[204:205], v252 offset:10240
    ds_read_b64_tr_b16 v[206:207], v252 offset:11520
    s_waitcnt lgkmcnt(12)
    v_mfma_f32_32x32x16_bf16 v[36:51], v[180:183], v[132:135], 0
    ds_read_b64_tr_b16 v[208:209], v252 offset:10304
    ds_read_b64_tr_b16 v[210:211], v252 offset:11584
    s_waitcnt lgkmcnt(12)
    v_mfma_f32_32x32x16_bf16 v[52:67], v[184:187], v[132:135], 0
    ds_read_b64_tr_b16 v[180:181], v252 offset:10368
    ds_read_b64_tr_b16 v[182:183], v252 offset:11648
    s_waitcnt lgkmcnt(12)
    v_mfma_f32_32x32x16_bf16 v[68:83], v[188:191], v[132:135], 0
    ds_read_b64_tr_b16 v[184:185], v252 offset:15360
    ds_read_b64_tr_b16 v[186:187], v252 offset:16640
    s_waitcnt lgkmcnt(12)
    v_mfma_f32_32x32x16_bf16 v[36:51], v[192:195], v[136:139], v[36:51]
    ds_read_b64_tr_b16 v[188:189], v252 offset:15424
    ds_read_b64_tr_b16 v[190:191], v252 offset:16704
    s_waitcnt lgkmcnt(12)
    v_mfma_f32_32x32x16_bf16 v[52:67], v[196:199], v[136:139], v[52:67]
    ds_read_b64_tr_b16 v[192:193], v252 offset:15488
    ds_read_b64_tr_b16 v[194:195], v252 offset:16768
    s_waitcnt lgkmcnt(12)
    v_mfma_f32_32x32x16_bf16 v[68:83], v[200:203], v[136:139], v[68:83]
    ds_read_b64_tr_b16 v[196:197], v252 offset:20480
    ds_read_b64_tr_b16 v[198:199], v252 offset:21760
    s_waitcnt lgkmcnt(12)
    v_mfma_f32_32x32x16_bf16 v[36:51], v[204:207], v[140:143], v[36:51]
    ds_read_b64_tr_b16 v[200:201], v252 offset:20544
    ds_read_b64_tr_b16 v[202:203], v252 offset:21824
    s_waitcnt lgkmcnt(12)
    v_mfma_f32_32x32x16_bf16 v[52:67], v[208:211], v[140:143], v[52:67]
    ds_read_b64_tr_b16 v[204:205], v252 offset:20608
    ds_read_b64_tr_b16 v[206:207], v252 offset:21888
    s_waitcnt lgkmcnt(12)
    v_mfma_f32_32x32x16_bf16 v[68:83], v[180:183], v[140:143], v[68:83]
    ds_read_b64_tr_b16 v[208:209], v252 offset:25600
    ds_read_b64_tr_b16 v[210:211], v252 offset:26880
    s_waitcnt lgkmcnt(12)
    v_mfma_f32_32x32x16_bf16 v[36:51], v[184:187], v[144:147], v[36:51]
    ds_read_b64_tr_b16 v[180:181], v252 offset:25664
    ds_read_b64_tr_b16 v[182:183], v252 offset:26944
    s_waitcnt lgkmcnt(12)
    v_mfma_f32_32x32x16_bf16 v[52:67], v[188:191], v[144:147], v[52:67]
    ds_read_b64_tr_b16 v[184:185], v252 offset:25728
    ds_read_b64_tr_b16 v[186:187], v252 offset:27008
    s_waitcnt lgkmcnt(12)
    v_mfma_f32_32x32x16_bf16 v[68:83], v[192:195], v[144:147], v[68:83]
    ds_read_b64_tr_b16 v[188:189], v252 offset:192
    ds_read_b64_tr_b16 v[190:191], v252 offset:1472
    s_waitcnt lgkmcnt(12)
    v_mfma_f32_32x32x16_bf16 v[36:51], v[196:199], v[148:151], v[36:51]
    ds_read_b64_tr_b16 v[192:193], v252 offset:256
    ds_read_b64_tr_b16 v[194:195], v252 offset:1536
    s_waitcnt lgkmcnt(12)
    v_mfma_f32_32x32x16_bf16 v[52:67], v[200:203], v[148:151], v[52:67]
    ds_read_b64_tr_b16 v[196:197], v252 offset:5312
    ds_read_b64_tr_b16 v[198:199], v252 offset:6592
    s_waitcnt lgkmcnt(12)
    v_mfma_f32_32x32x16_bf16 v[68:83], v[204:207], v[148:151], v[68:83]
    ds_read_b64_tr_b16 v[200:201], v252 offset:5376
    ds_read_b64_tr_b16 v[202:203], v252 offset:6656
    s_waitcnt lgkmcnt(12)
    v_mfma_f32_32x32x16_bf16 v[36:51], v[208:211], v[152:155], v[36:51]
    ds_read_b64_tr_b16 v[204:205], v252 offset:10432
    ds_read_b64_tr_b16 v[206:207], v252 offset:11712
    s_waitcnt lgkmcnt(12)
    v_mfma_f32_32x32x16_bf16 v[52:67], v[180:183], v[152:155], v[52:67]
    ds_read_b64_tr_b16 v[208:209], v252 offset:10496
    ds_read_b64_tr_b16 v[210:211], v252 offset:11776
    s_waitcnt lgkmcnt(12)
    v_mfma_f32_32x32x16_bf16 v[68:83], v[184:187], v[152:155], v[68:83]
    ds_read_b64_tr_b16 v[180:181], v252 offset:15552
    ds_read_b64_tr_b16 v[182:183], v252 offset:16832
    s_waitcnt lgkmcnt(12)
    v_mfma_f32_32x32x16_bf16 v[84:99], v[132:135], v[188:191], 0
    ds_read_b64_tr_b16 v[184:185], v252 offset:15616
    ds_read_b64_tr_b16 v[186:187], v252 offset:16896
    s_add_u32 s35, s48, 1
    s_lshl_b32 s35, s35, 2
    s_add_u32 s35, s35, 153664
    v_mov_b32 v248, s35
    ds_read_b32 v249, v248
    s_waitcnt lgkmcnt(13)
    v_mfma_f32_32x32x16_bf16 v[100:115], v[132:135], v[192:195], 0
    ds_read_b64_tr_b16 v[188:189], v252 offset:20672
    ds_read_b64_tr_b16 v[190:191], v252 offset:21952
    s_waitcnt lgkmcnt(13)
    v_mfma_f32_32x32x16_bf16 v[84:99], v[136:139], v[196:199], v[84:99]
    ds_read_b64_tr_b16 v[192:193], v252 offset:20736
    ds_read_b64_tr_b16 v[194:195], v252 offset:22016
    v_pk_mul_f32 v[36:37], v[36:37], s[44:45]
    v_pk_mul_f32 v[38:39], v[38:39], s[44:45]
    v_pk_mul_f32 v[40:41], v[40:41], s[44:45]
    s_waitcnt lgkmcnt(13)
    v_mfma_f32_32x32x16_bf16 v[100:115], v[136:139], v[200:203], v[100:115]
    ds_read_b64_tr_b16 v[196:197], v252 offset:25792
    ds_read_b64_tr_b16 v[198:199], v252 offset:27072
    v_pk_mul_f32 v[42:43], v[42:43], s[44:45]
    v_pk_mul_f32 v[44:45], v[44:45], s[44:45]
    v_pk_mul_f32 v[46:47], v[46:47], s[44:45]
    s_waitcnt lgkmcnt(13)
    v_mfma_f32_32x32x16_bf16 v[84:99], v[140:143], v[204:207], v[84:99]
    ds_read_b64_tr_b16 v[200:201], v252 offset:25856
    ds_read_b64_tr_b16 v[202:203], v252 offset:27136
    v_pk_mul_f32 v[48:49], v[48:49], s[44:45]
    v_pk_mul_f32 v[50:51], v[50:51], s[44:45]
    v_pk_mul_f32 v[52:53], v[52:53], s[44:45]
    s_waitcnt lgkmcnt(13)
    v_mfma_f32_32x32x16_bf16 v[100:115], v[140:143], v[208:211], v[100:115]
    ds_read_b64_tr_b16 v[204:205], v252 offset:0
    ds_read_b64_tr_b16 v[206:207], v252 offset:1280
    v_pk_mul_f32 v[54:55], v[54:55], s[44:45]
    v_pk_mul_f32 v[56:57], v[56:57], s[44:45]
    v_pk_mul_f32 v[58:59], v[58:59], s[44:45]
    s_waitcnt lgkmcnt(13)
    v_mfma_f32_32x32x16_bf16 v[84:99], v[144:147], v[180:183], v[84:99]
    ds_read_b64_tr_b16 v[208:209], v252 offset:64
    ds_read_b64_tr_b16 v[210:211], v252 offset:1344
    v_cvt_pk_bf16_f32 v212, v60, v61
    v_cvt_pk_bf16_f32 v213, v62, v63
    v_cvt_pk_bf16_f32 v214, v64, v65
    s_waitcnt lgkmcnt(12)
    v_readfirstlane_b32 s34, v249
    s_cmp_eq_u32 s34, 1
    s_cbranch_scc0 L_xslow1
L_xd1:
    ds_read_b128 v[156:159], v245 offset:6400
    ds_read_b128 v[160:163], v246 offset:6400
    ds_read_b128 v[164:167], v245 offset:6464
    ds_read_b128 v[168:171], v246 offset:6464
    ds_read_b128 v[172:175], v245 offset:6528
    ds_read_b128 v[176:179], v246 offset:6528
    v_mfma_f32_32x32x16_bf16 v[100:115], v[144:147], v[184:187], v[100:115]
    ds_read_b64_tr_b16 v[180:181], v252 offset:128
    ds_read_b64_tr_b16 v[182:183], v252 offset:1408
    v_cvt_pk_bf16_f32 v215, v66, v67
    v_cvt_pk_bf16_f32 v216, v68, v69
    v_cvt_pk_bf16_f32 v217, v70, v71
    s_waitcnt lgkmcnt(15)
    v_mfma_f32_32x32x16_bf16 v[84:99], v[148:151], v[188:191], v[84:99]
    ds_read_b64_tr_b16 v[184:185], v252 offset:5120
    ds_read_b64_tr_b16 v[186:187], v252 offset:6400
    v_cvt_pk_bf16_f32 v218, v72, v73
    v_cvt_pk_bf16_f32 v219, v74, v75
    v_cvt_pk_bf16_f32 v220, v76, v77
    v_mfma_f32_32x32x16_bf16 v[100:115], v[148:151], v[192:195], v[100:115]
    ds_read_b64_tr_b16 v[188:189], v252 offset:5184
    ds_read_b64_tr_b16 v[190:191], v252 offset:6464
    v_cvt_pk_bf16_f32 v221, v78, v79
    v_cvt_pk_bf16_f32 v222, v80, v81
    v_cvt_pk_bf16_f32 v223, v82, v83
    s_waitcnt lgkmcnt(15)
    v_mfma_f32_32x32x16_bf16 v[84:99], v[152:155], v[196:199], v[84:99]
    ds_read_b64_tr_b16 v[192:193], v252 offset:5248
    ds_read_b64_tr_b16 v[194:195], v252 offset:6528
    ds_write_b128 v236, v[212:215] offset:0
    ds_write_b128 v236, v[216:219] offset:1024
    ds_write_b128 v236, v[220:223] offset:2048
    v_mfma_f32_32x32x16_bf16 v[100:115], v[152:155], v[200:203], v[100:115]
    ds_read_b64_tr_b16 v[196:197], v252 offset:10240
    ds_read_b64_tr_b16 v[198:199], v252 offset:11520
    s_add_u32 s97, s96, 0
    buffer_store_dwordx4 v[212:215], v237, s[20:23], s97 offen offset:0
    buffer_store_dwordx4 v[216:219], v237, s[20:23], s97 offen offset:1024
    buffer_store_dwordx4 v[220:223], v237, s[20:23], s97 offen offset:2048
    s_cmp_eq_u32 s98, 0
    s_cbranch_scc0 L_qa0
    v_cvt_pk_bf16_f32 v12, v36, v37
    v_cvt_pk_bf16_f32 v13, v38, v39
    v_cvt_pk_bf16_f32 v14, v40, v41
    v_cvt_pk_bf16_f32 v15, v42, v43
    v_cvt_pk_bf16_f32 v16, v44, v45
    v_cvt_pk_bf16_f32 v17, v46, v47
    v_cvt_pk_bf16_f32 v18, v48, v49
    v_cvt_pk_bf16_f32 v19, v50, v51
    v_cvt_pk_bf16_f32 v20, v52, v53
    v_cvt_pk_bf16_f32 v21, v54, v55
    v_cvt_pk_bf16_f32 v22, v56, v57
    v_cvt_pk_bf16_f32 v23, v58, v59
    s_branch L_qb0
L_qa0:
    v_cvt_pk_bf16_f32 v0, v36, v37
    v_cvt_pk_bf16_f32 v1, v38, v39
    v_cvt_pk_bf16_f32 v2, v40, v41
    v_cvt_pk_bf16_f32 v3, v42, v43
    v_cvt_pk_bf16_f32 v4, v44, v45
    v_cvt_pk_bf16_f32 v5, v46, v47
    v_cvt_pk_bf16_f32 v6, v48, v49
    v_cvt_pk_bf16_f32 v7, v50, v51
    v_cvt_pk_bf16_f32 v8, v52, v53
    v_cvt_pk_bf16_f32 v9, v54, v55
    v_cvt_pk_bf16_f32 v10, v56, v57
    v_cvt_pk_bf16_f32 v11, v58, v59
L_qb0:
    s_waitcnt lgkmcnt(15)
    v_mfma_f32_32x32x16_bf16 v[36:51], v[204:207], v[156:159], 0
    ds_read_b64_tr_b16 v[200:201], v252 offset:10304
    ds_read_b64_tr_b16 v[202:203], v252 offset:11584
    v_mfma_f32_32x32x16_bf16 v[52:67], v[208:211], v[156:159], 0
    ds_read_b64_tr_b16 v[204:205], v252 offset:10368
    ds_read_b64_tr_b16 v[206:207], v252 offset:11648
    s_waitcnt lgkmcnt(15)
    v_mfma_f32_32x32x16_bf16 v[68:83], v[180:183], v[156:159], 0
    ds_read_b64_tr_b16 v[208:209], v252 offset:15360
    ds_read_b64_tr_b16 v[210:211], v252 offset:16640
    v_cvt_pk_bf16_f32 v116, v84, v85
    s_waitcnt lgkmcnt(15)
    v_mfma_f32_32x32x16_bf16 v[36:51], v[184:187], v[160:163], v[36:51]
    ds_read_b64_tr_b16 v[180:181], v252 offset:15424
    ds_read_b64_tr_b16 v[182:183], v252 offset:16704
    v_cvt_pk_bf16_f32 v117, v86, v87
    v_cvt_pk_bf16_f32 v118, v88, v89
    s_waitcnt lgkmcnt(15)
    v_mfma_f32_32x32x16_bf16 v[52:67], v[188:191], v[160:163], v[52:67]
    ds_read_b64_tr_b16 v[184:185], v252 offset:15488
    ds_read_b64_tr_b16 v[186:187], v252 offset:16768
    v_cvt_pk_bf16_f32 v119, v90, v91
    v_cvt_pk_bf16_f32 v120, v92, v93
    s_waitcnt lgkmcnt(15)
    v_mfma_f32_32x32x16_bf16 v[68:83], v[192:195], v[160:163], v[68:83]
    ds_read_b64_tr_b16 v[188:189], v252 offset:20480
    ds_read_b64_tr_b16 v[190:191], v252 offset:21760
    v_cvt_pk_bf16_f32 v121, v94, v95
    v_cvt_pk_bf16_f32 v122, v96, v97
    s_waitcnt lgkmcnt(12)
    v_mfma_f32_32x32x16_bf16 v[36:51], v[196:199], v[164:167], v[36:51]
    ds_read_b64_tr_b16 v[192:193], v252 offset:20544
    ds_read_b64_tr_b16 v[194:195], v252 offset:21824
    v_cvt_pk_bf16_f32 v123, v98, v99
    ds_write_b128 v239, v[116:119] offset:3072
    s_waitcnt lgkmcnt(13)
    v_mfma_f32_32x32x16_bf16 v[52:67], v[200:203], v[164:167], v[52:67]
    ds_read_b64_tr_b16 v[196:197], v252 offset:20608
    ds_read_b64_tr_b16 v[198:199], v252 offset:21888
    ds_write_b128 v239, v[120:123] offset:4096
    s_add_u32 s97, s96, 3072
    s_waitcnt lgkmcnt(14)
    v_mfma_f32_32x32x16_bf16 v[68:83], v[204:207], v[164:167], v[68:83]
    ds_read_b64_tr_b16 v[200:201], v252 offset:25600
    ds_read_b64_tr_b16 v[202:203], v252 offset:26880
    buffer_store_dwordx4 v[116:119], v254, s[20:23], s97 offen
    buffer_store_dwordx4 v[120:123], v254, s[20:23], s97 offen offset:1024
    s_waitcnt lgkmcnt(14)
    v_mfma_f32_32x32x16_bf16 v[36:51], v[208:211], v[168:171], v[36:51]
    ds_read_b64_tr_b16 v[204:205], v252 offset:25664
    ds_read_b64_tr_b16 v[206:207], v252 offset:26944
    v_cvt_pk_bf16_f32 v124, v100, v101
    s_waitcnt lgkmcnt(14)
    v_mfma_f32_32x32x16_bf16 v[52:67], v[180:183], v[168:171], v[52:67]
    ds_read_b64_tr_b16 v[208:209], v252 offset:25728
    ds_read_b64_tr_b16 v[210:211], v252 offset:27008
    v_cvt_pk_bf16_f32 v125, v102, v103
    v_cvt_pk_bf16_f32 v126, v104, v105
    s_waitcnt lgkmcnt(14)
    v_mfma_f32_32x32x16_bf16 v[68:83], v[184:187], v[168:171], v[68:83]
    ds_read_b64_tr_b16 v[180:181], v252 offset:192
    ds_read_b64_tr_b16 v[182:183], v252 offset:1472
    v_cvt_pk_bf16_f32 v127, v106, v107
    v_cvt_pk_bf16_f32 v128, v108, v109
    s_waitcnt lgkmcnt(14)
    v_mfma_f32_32x32x16_bf16 v[36:51], v[188:191], v[172:175], v[36:51]
    ds_read_b64_tr_b16 v[184:185], v252 offset:256
    ds_read_b64_tr_b16 v[186:187], v252 offset:1536
    v_cvt_pk_bf16_f32 v129, v110, v111
    v_cvt_pk_bf16_f32 v130, v112, v113
    s_waitcnt lgkmcnt(14)
    v_mfma_f32_32x32x16_bf16 v[52:67], v[192:195], v[172:175], v[52:67]
    ds_read_b64_tr_b16 v[188:189], v252 offset:5312
    ds_read_b64_tr_b16 v[190:191], v252 offset:6592
    v_cvt_pk_bf16_f32 v131, v114, v115
    s_nop 0
    s_waitcnt lgkmcnt(13)
    v_mfma_f32_32x32x16_bf16 v[68:83], v[196:199], v[172:175], v[68:83]
    ds_read_b64_tr_b16 v[192:193], v252 offset:5376
    ds_read_b64_tr_b16 v[194:195], v252 offset:6656
    v_permlane16_swap_b32 v124, v128
    v_permlane16_swap_b32 v125, v129
    s_waitcnt lgkmcnt(12)
    v_mfma_f32_32x32x16_bf16 v[36:51], v[200:203], v[176:179], v[36:51]
    ds_read_b64_tr_b16 v[196:197], v252 offset:10432
    ds_read_b64_tr_b16 v[198:199], v252 offset:11712
    v_permlane16_swap_b32 v126, v130
    v_permlane16_swap_b32 v127, v131
    s_waitcnt lgkmcnt(12)
    v_mfma_f32_32x32x16_bf16 v[52:67], v[204:207], v[176:179], v[52:67]
    ds_read_b64_tr_b16 v[200:201], v252 offset:10496
    ds_read_b64_tr_b16 v[202:203], v252 offset:11776
    ds_write_b128 v234, v[124:127] offset:5120
    buffer_store_dwordx4 v[124:127], v235, s[20:23], s97 offen offset:2048
    s_waitcnt lgkmcnt(13)
    v_mfma_f32_32x32x16_bf16 v[68:83], v[208:211], v[176:179], v[68:83]
    ds_read_b64_tr_b16 v[204:205], v252 offset:15552
    ds_read_b64_tr_b16 v[206:207], v252 offset:16832
    s_waitcnt lgkmcnt(13)
    v_mfma_f32_32x32x16_bf16 v[84:99], v[156:159], v[180:183], 0
    ds_read_b64_tr_b16 v[208:209], v252 offset:15616
    ds_read_b64_tr_b16 v[210:211], v252 offset:16896
    s_add_u32 s35, s48, 2
    s_lshl_b32 s35, s35, 2
    s_add_u32 s35, s35, 153664
    v_mov_b32 v248, s35
    ds_read_b32 v249, v248
    s_waitcnt lgkmcnt(14)
    v_mfma_f32_32x32x16_bf16 v[100:115], v[156:159], v[184:187], 0
    ds_read_b64_tr_b16 v[180:181], v252 offset:20672
    ds_read_b64_tr_b16 v[182:183], v252 offset:21952
    s_waitcnt lgkmcnt(14)
    v_mfma_f32_32x32x16_bf16 v[84:99], v[160:163], v[188:191], v[84:99]
    ds_read_b64_tr_b16 v[184:185], v252 offset:20736
    ds_read_b64_tr_b16 v[186:187], v252 offset:22016
    v_pk_mul_f32 v[36:37], v[36:37], s[44:45]
    v_pk_mul_f32 v[38:39], v[38:39], s[44:45]
    v_pk_mul_f32 v[40:41], v[40:41], s[44:45]
    s_waitcnt lgkmcnt(14)
    v_mfma_f32_32x32x16_bf16 v[100:115], v[160:163], v[192:195], v[100:115]
    ds_read_b64_tr_b16 v[188:189], v252 offset:25792
    ds_read_b64_tr_b16 v[190:191], v252 offset:27072
    v_pk_mul_f32 v[42:43], v[42:43], s[44:45]
    v_pk_mul_f32 v[44:45], v[44:45], s[44:45]
    v_pk_mul_f32 v[46:47], v[46:47], s[44:45]
    s_waitcnt lgkmcnt(14)
    v_mfma_f32_32x32x16_bf16 v[84:99], v[164:167], v[196:199], v[84:99]
    ds_read_b64_tr_b16 v[192:193], v252 offset:25856
    ds_read_b64_tr_b16 v[194:195], v252 offset:27136
    v_pk_mul_f32 v[48:49], v[48:49], s[44:45]
    v_pk_mul_f32 v[50:51], v[50:51], s[44:45]
    v_pk_mul_f32 v[52:53], v[52:53], s[44:45]
    s_waitcnt lgkmcnt(14)
    v_mfma_f32_32x32x16_bf16 v[100:115], v[164:167], v[200:203], v[100:115]
    ds_read_b64_tr_b16 v[196:197], v252 offset:0
    ds_read_b64_tr_b16 v[198:199], v252 offset:1280
    v_pk_mul_f32 v[54:55], v[54:55], s[44:45]
    v_pk_mul_f32 v[56:57], v[56:57], s[44:45]
    v_pk_mul_f32 v[58:59], v[58:59], s[44:45]
    s_waitcnt lgkmcnt(13)
    v_mfma_f32_32x32x16_bf16 v[84:99], v[168:171], v[204:207], v[84:99]
    ds_read_b64_tr_b16 v[200:201], v252 offset:64
    ds_read_b64_tr_b16 v[202:203], v252 offset:1344
    v_cvt_pk_bf16_f32 v212, v60, v61
    v_cvt_pk_bf16_f32 v213, v62, v63
    v_cvt_pk_bf16_f32 v214, v64, v65
    s_waitcnt lgkmcnt(12)
    v_readfirstlane_b32 s34, v249
    s_cmp_eq_u32 s34, 1
    s_cbranch_scc0 L_xslow2
L_xd2:
    ds_read_b128 v[132:135], v245 offset:12800
    ds_read_b128 v[136:139], v246 offset:12800
    ds_read_b128 v[140:143], v245 offset:12864
    ds_read_b128 v[144:147], v246 offset:12864
    ds_read_b128 v[148:151], v245 offset:12928
    ds_read_b128 v[152:155], v246 offset:12928
    v_mfma_f32_32x32x16_bf16 v[100:115], v[168:171], v[208:211], v[100:115]
    ds_read_b64_tr_b16 v[204:205], v252 offset:128
    ds_read_b64_tr_b16 v[206:207], v252 offset:1408
    v_cvt_pk_bf16_f32 v215, v66, v67
    v_cvt_pk_bf16_f32 v216, v68, v69
    v_cvt_pk_bf16_f32 v217, v70, v71
    s_waitcnt lgkmcnt(15)
    v_mfma_f32_32x32x16_bf16 v[84:99], v[172:175], v[180:183], v[84:99]
    ds_read_b64_tr_b16 v[208:209], v252 offset:5120
    ds_read_b64_tr_b16 v[210:211], v252 offset:6400
    v_cvt_pk_bf16_f32 v218, v72, v73
    v_cvt_pk_bf16_f32 v219, v74, v75
    v_cvt_pk_bf16_f32 v220, v76, v77
    v_mfma_f32_32x32x16_bf16 v[100:115], v[172:175], v[184:187], v[100:115]
    ds_read_b64_tr_b16 v[180:181], v252 offset:5184
    ds_read_b64_tr_b16 v[182:183], v252 offset:6464
    v_cvt_pk_bf16_f32 v221, v78, v79
    v_cvt_pk_bf16_f32 v222, v80, v81
    v_cvt_pk_bf16_f32 v223, v82, v83
    s_waitcnt lgkmcnt(15)
    v_mfma_f32_32x32x16_bf16 v[84:99], v[176:179], v[188:191], v[84:99]
    ds_read_b64_tr_b16 v[184:185], v252 offset:5248
    ds_read_b64_tr_b16 v[186:187], v252 offset:6528
    ds_write_b128 v236, v[212:215] offset:6400
    ds_write_b128 v236, v[216:219] offset:7424
    ds_write_b128 v236, v[220:223] offset:8448
    v_mfma_f32_32x32x16_bf16 v[100:115], v[176:179], v[192:195], v[100:115]
    ds_read_b64_tr_b16 v[188:189], v252 offset:10240
    ds_read_b64_tr_b16 v[190:191], v252 offset:11520
    s_add_u32 s97, s96, 6144
    buffer_store_dwordx4 v[212:215], v237, s[20:23], s97 offen offset:0
    buffer_store_dwordx4 v[216:219], v237, s[20:23], s97 offen offset:1024
    buffer_store_dwordx4 v[220:223], v237, s[20:23], s97 offen offset:2048
    s_cmp_eq_u32 s98, 0
    s_cbranch_scc0 L_qa1
    v_cvt_pk_bf16_f32 v0, v36, v37
    v_cvt_pk_bf16_f32 v1, v38, v39
    v_cvt_pk_bf16_f32 v2, v40, v41
    v_cvt_pk_bf16_f32 v3, v42, v43
    v_cvt_pk_bf16_f32 v4, v44, v45
    v_cvt_pk_bf16_f32 v5, v46, v47
    v_cvt_pk_bf16_f32 v6, v48, v49
    v_cvt_pk_bf16_f32 v7, v50, v51
    v_cvt_pk_bf16_f32 v8, v52, v53
    v_cvt_pk_bf16_f32 v9, v54, v55
    v_cvt_pk_bf16_f32 v10, v56, v57
    v_cvt_pk_bf16_f32 v11, v58, v59
    s_branch L_qb1
L_qa1:
    v_cvt_pk_bf16_f32 v24, v36, v37
    v_cvt_pk_bf16_f32 v25, v38, v39
    v_cvt_pk_bf16_f32 v26, v40, v41
    v_cvt_pk_bf16_f32 v27, v42, v43
    v_cvt_pk_bf16_f32 v28, v44, v45
    v_cvt_pk_bf16_f32 v29, v46, v47
    v_cvt_pk_bf16_f32 v30, v48, v49
    v_cvt_pk_bf16_f32 v31, v50, v51
    v_cvt_pk_bf16_f32 v32, v52, v53
    v_cvt_pk_bf16_f32 v33, v54, v55
    v_cvt_pk_bf16_f32 v34, v56, v57
    v_cvt_pk_bf16_f32 v35, v58, v59
L_qb1:
    s_waitcnt lgkmcnt(15)
    v_mfma_f32_32x32x16_bf16 v[36:51], v[196:199], v[132:135], 0
    ds_read_b64_tr_b16 v[192:193], v252 offset:10304
    ds_read_b64_tr_b16 v[194:195], v252 offset:11584
    v_mfma_f32_32x32x16_bf16 v[52:67], v[200:203], v[132:135], 0
    ds_read_b64_tr_b16 v[196:197], v252 offset:10368
    ds_read_b64_tr_b16 v[198:199], v252 offset:11648
    s_waitcnt lgkmcnt(15)
    v_mfma_f32_32x32x16_bf16 v[68:83], v[204:207], v[132:135], 0
    ds_read_b64_tr_b16 v[200:201], v252 offset:15360
    ds_read_b64_tr_b16 v[202:203], v252 offset:16640
    v_cvt_pk_bf16_f32 v116, v84, v85
    s_waitcnt lgkmcnt(15)
    v_mfma_f32_32x32x16_bf16 v[36:51], v[208:211], v[136:139], v[36:51]
    ds_read_b64_tr_b16 v[204:205], v252 offset:15424
    ds_read_b64_tr_b16 v[206:207], v252 offset:16704
    v_cvt_pk_bf16_f32 v117, v86, v87
    v_cvt_pk_bf16_f32 v118, v88, v89
    s_waitcnt lgkmcnt(15)
    v_mfma_f32_32x32x16_bf16 v[52:67], v[180:183], v[136:139], v[52:67]
    ds_read_b64_tr_b16 v[208:209], v252 offset:15488
    ds_read_b64_tr_b16 v[210:211], v252 offset:16768
    v_cvt_pk_bf16_f32 v119, v90, v91
    v_cvt_pk_bf16_f32 v120, v92, v93
    s_waitcnt lgkmcnt(15)
    v_mfma_f32_32x32x16_bf16 v[68:83], v[184:187], v[136:139], v[68:83]
    ds_read_b64_tr_b16 v[180:181], v252 offset:20480
    ds_read_b64_tr_b16 v[182:183], v252 offset:21760
    v_cvt_pk_bf16_f32 v121, v94, v95
    v_cvt_pk_bf16_f32 v122, v96, v97
    s_waitcnt lgkmcnt(12)
    v_mfma_f32_32x32x16_bf16 v[36:51], v[188:191], v[140:143], v[36:51]
    ds_read_b64_tr_b16 v[184:185], v252 offset:20544
    ds_read_b64_tr_b16 v[186:187], v252 offset:21824
    v_cvt_pk_bf16_f32 v123, v98, v99
    ds_write_b128 v239, v[116:119] offset:9472
    s_waitcnt lgkmcnt(13)
    v_mfma_f32_32x32x16_bf16 v[52:67], v[192:195], v[140:143], v[52:67]
    ds_read_b64_tr_b16 v[188:189], v252 offset:20608
    ds_read_b64_tr_b16 v[190:191], v252 offset:21888
    ds_write_b128 v239, v[120:123] offset:10496
    s_add_u32 s97, s96, 9216
    s_waitcnt lgkmcnt(14)
    v_mfma_f32_32x32x16_bf16 v[68:83], v[196:199], v[140:143], v[68:83]
    ds_read_b64_tr_b16 v[192:193], v252 offset:25600
    ds_read_b64_tr_b16 v[194:195], v252 offset:26880
    buffer_store_dwordx4 v[116:119], v254, s[20:23], s97 offen
    buffer_store_dwordx4 v[120:123], v254, s[20:23], s97 offen offset:1024
    s_waitcnt lgkmcnt(14)
    v_mfma_f32_32x32x16_bf16 v[36:51], v[200:203], v[144:147], v[36:51]
    ds_read_b64_tr_b16 v[196:197], v252 offset:25664
    ds_read_b64_tr_b16 v[198:199], v252 offset:26944
    v_cvt_pk_bf16_f32 v124, v100, v101
    s_waitcnt lgkmcnt(14)
    v_mfma_f32_32x32x16_bf16 v[52:67], v[204:207], v[144:147], v[52:67]
    ds_read_b64_tr_b16 v[200:201], v252 offset:25728
    ds_read_b64_tr_b16 v[202:203], v252 offset:27008
    v_cvt_pk_bf16_f32 v125, v102, v103
    v_cvt_pk_bf16_f32 v126, v104, v105
    s_waitcnt lgkmcnt(14)
    v_mfma_f32_32x32x16_bf16 v[68:83], v[208:211], v[144:147], v[68:83]
    ds_read_b64_tr_b16 v[204:205], v252 offset:192
    ds_read_b64_tr_b16 v[206:207], v252 offset:1472
    v_cvt_pk_bf16_f32 v127, v106, v107
    v_cvt_pk_bf16_f32 v128, v108, v109
    s_waitcnt lgkmcnt(14)
    v_mfma_f32_32x32x16_bf16 v[36:51], v[180:183], v[148:151], v[36:51]
    ds_read_b64_tr_b16 v[208:209], v252 offset:256
    ds_read_b64_tr_b16 v[210:211], v252 offset:1536
    v_cvt_pk_bf16_f32 v129, v110, v111
    v_cvt_pk_bf16_f32 v130, v112, v113
    s_waitcnt lgkmcnt(14)
    v_mfma_f32_32x32x16_bf16 v[52:67], v[184:187], v[148:151], v[52:67]
    ds_read_b64_tr_b16 v[180:181], v252 offset:5312
    ds_read_b64_tr_b16 v[182:183], v252 offset:6592
    v_cvt_pk_bf16_f32 v131, v114, v115
    s_nop 0
    s_waitcnt lgkmcnt(13)
    v_mfma_f32_32x32x16_bf16 v[68:83], v[188:191], v[148:151], v[68:83]
    ds_read_b64_tr_b16 v[184:185], v252 offset:5376
    ds_read_b64_tr_b16 v[186:187], v252 offset:6656
    v_permlane16_swap_b32 v124, v128
    v_permlane16_swap_b32 v125, v129
    s_waitcnt lgkmcnt(12)
    v_mfma_f32_32x32x16_bf16 v[36:51], v[192:195], v[152:155], v[36:51]
    ds_read_b64_tr_b16 v[188:189], v252 offset:10432
    ds_read_b64_tr_b16 v[190:191], v252 offset:11712
    v_permlane16_swap_b32 v126, v130
    v_permlane16_swap_b32 v127, v131
    s_waitcnt lgkmcnt(12)
    v_mfma_f32_32x32x16_bf16 v[52:67], v[196:199], v[152:155], v[52:67]
    ds_read_b64_tr_b16 v[192:193], v252 offset:10496
    ds_read_b64_tr_b16 v[194:195], v252 offset:11776
    ds_write_b128 v234, v[124:127] offset:11520
    buffer_store_dwordx4 v[124:127], v235, s[20:23], s97 offen offset:2048
    s_waitcnt lgkmcnt(13)
    v_mfma_f32_32x32x16_bf16 v[68:83], v[200:203], v[152:155], v[68:83]
    ds_read_b64_tr_b16 v[196:197], v252 offset:15552
    ds_read_b64_tr_b16 v[198:199], v252 offset:16832
    s_waitcnt lgkmcnt(13)
    v_mfma_f32_32x32x16_bf16 v[84:99], v[132:135], v[204:207], 0
    ds_read_b64_tr_b16 v[200:201], v252 offset:15616
    ds_read_b64_tr_b16 v[202:203], v252 offset:16896
    s_waitcnt lgkmcnt(13)
    v_mfma_f32_32x32x16_bf16 v[100:115], v[132:135], v[208:211], 0
    ds_read_b64_tr_b16 v[204:205], v252 offset:20672
    ds_read_b64_tr_b16 v[206:207], v252 offset:21952
    s_waitcnt lgkmcnt(13)
    v_mfma_f32_32x32x16_bf16 v[84:99], v[136:139], v[180:183], v[84:99]
    ds_read_b64_tr_b16 v[208:209], v252 offset:20736
    ds_read_b64_tr_b16 v[210:211], v252 offset:22016
    v_pk_mul_f32 v[36:37], v[36:37], s[44:45]
    v_pk_mul_f32 v[38:39], v[38:39], s[44:45]
    v_pk_mul_f32 v[40:41], v[40:41], s[44:45]
    s_waitcnt lgkmcnt(13)
    v_mfma_f32_32x32x16_bf16 v[100:115], v[136:139], v[184:187], v[100:115]
    ds_read_b64_tr_b16 v[180:181], v252 offset:25792
    ds_read_b64_tr_b16 v[182:183], v252 offset:27072
    v_pk_mul_f32 v[42:43], v[42:43], s[44:45]
    v_pk_mul_f32 v[44:45], v[44:45], s[44:45]
    v_pk_mul_f32 v[46:47], v[46:47], s[44:45]
    s_waitcnt lgkmcnt(13)
    v_mfma_f32_32x32x16_bf16 v[84:99], v[140:143], v[188:191], v[84:99]
    ds_read_b64_tr_b16 v[184:185], v252 offset:25856
    ds_read_b64_tr_b16 v[186:187], v252 offset:27136
    v_pk_mul_f32 v[48:49], v[48:49], s[44:45]
    v_pk_mul_f32 v[50:51], v[50:51], s[44:45]
    v_pk_mul_f32 v[52:53], v[52:53], s[44:45]
    s_waitcnt lgkmcnt(13)
    v_mfma_f32_32x32x16_bf16 v[100:115], v[140:143], v[192:195], v[100:115]
    v_pk_mul_f32 v[54:55], v[54:55], s[44:45]
    v_pk_mul_f32 v[56:57], v[56:57], s[44:45]
    v_pk_mul_f32 v[58:59], v[58:59], s[44:45]
    s_waitcnt lgkmcnt(10)
    v_mfma_f32_32x32x16_bf16 v[84:99], v[144:147], v[196:199], v[84:99]
    v_cvt_pk_bf16_f32 v212, v60, v61
    v_cvt_pk_bf16_f32 v213, v62, v63
    v_cvt_pk_bf16_f32 v214, v64, v65
    s_waitcnt lgkmcnt(8)
    v_mfma_f32_32x32x16_bf16 v[100:115], v[144:147], v[200:203], v[100:115]
    v_cvt_pk_bf16_f32 v215, v66, v67
    v_cvt_pk_bf16_f32 v216, v68, v69
    v_cvt_pk_bf16_f32 v217, v70, v71
    s_waitcnt lgkmcnt(6)
    v_mfma_f32_32x32x16_bf16 v[84:99], v[148:151], v[204:207], v[84:99]
    v_cvt_pk_bf16_f32 v218, v72, v73
    v_cvt_pk_bf16_f32 v219, v74, v75
    v_cvt_pk_bf16_f32 v220, v76, v77
    s_waitcnt lgkmcnt(4)
    v_mfma_f32_32x32x16_bf16 v[100:115], v[148:151], v[208:211], v[100:115]
    v_cvt_pk_bf16_f32 v221, v78, v79
    v_cvt_pk_bf16_f32 v222, v80, v81
    v_cvt_pk_bf16_f32 v223, v82, v83
    s_waitcnt lgkmcnt(2)
    v_mfma_f32_32x32x16_bf16 v[84:99], v[152:155], v[180:183], v[84:99]
    ds_write_b128 v236, v[212:215] offset:12800
    ds_write_b128 v236, v[216:219] offset:13824
    ds_write_b128 v236, v[220:223] offset:14848
    s_waitcnt lgkmcnt(3)
    v_mfma_f32_32x32x16_bf16 v[100:115], v[152:155], v[184:187], v[100:115]
    s_add_u32 s97, s96, 12288
    buffer_store_dwordx4 v[212:215], v237, s[20:23], s97 offen offset:0
    buffer_store_dwordx4 v[216:219], v237, s[20:23], s97 offen offset:1024
    buffer_store_dwordx4 v[220:223], v237, s[20:23], s97 offen offset:2048
    s_cmp_eq_u32 s98, 0
    s_cbranch_scc0 L_qa2
    v_cvt_pk_bf16_f32 v24, v36, v37
    v_cvt_pk_bf16_f32 v25, v38, v39
    v_cvt_pk_bf16_f32 v26, v40, v41
    v_cvt_pk_bf16_f32 v27, v42, v43
    v_cvt_pk_bf16_f32 v28, v44, v45
    v_cvt_pk_bf16_f32 v29, v46, v47
    v_cvt_pk_bf16_f32 v30, v48, v49
    v_cvt_pk_bf16_f32 v31, v50, v51
    v_cvt_pk_bf16_f32 v32, v52, v53
    v_cvt_pk_bf16_f32 v33, v54, v55
    v_cvt_pk_bf16_f32 v34, v56, v57
    v_cvt_pk_bf16_f32 v35, v58, v59
    s_branch L_qb2
L_qa2:
    v_cvt_pk_bf16_f32 v12, v36, v37
    v_cvt_pk_bf16_f32 v13, v38, v39
    v_cvt_pk_bf16_f32 v14, v40, v41
    v_cvt_pk_bf16_f32 v15, v42, v43
    v_cvt_pk_bf16_f32 v16, v44, v45
    v_cvt_pk_bf16_f32 v17, v46, v47
    v_cvt_pk_bf16_f32 v18, v48, v49
    v_cvt_pk_bf16_f32 v19, v50, v51
    v_cvt_pk_bf16_f32 v20, v52, v53
    v_cvt_pk_bf16_f32 v21, v54, v55
    v_cvt_pk_bf16_f32 v22, v56, v57
    v_cvt_pk_bf16_f32 v23, v58, v59
L_qb2:
    s_nop 3
    v_mfma_f32_32x32x16_bf16 v[132:147], v[212:215], v[0:3], 0
    v_mfma_f32_32x32x16_bf16 v[132:147], v[216:219], v[4:7], v[132:147]
    v_cvt_pk_bf16_f32 v116, v84, v85
    v_cvt_pk_bf16_f32 v117, v86, v87
    v_cvt_pk_bf16_f32 v118, v88, v89
    v_mfma_f32_32x32x16_bf16 v[132:147], v[220:223], v[8:11], v[132:147]
    v_cvt_pk_bf16_f32 v119, v90, v91
    v_cvt_pk_bf16_f32 v120, v92, v93
    v_cvt_pk_bf16_f32 v121, v94, v95
    v_cvt_pk_bf16_f32 v122, v96, v97
    v_mfma_f32_32x32x16_bf16 v[148:163], v[212:215], v[12:15], 0
    v_cvt_pk_bf16_f32 v123, v98, v99
    ds_write_b128 v239, v[116:119] offset:15872
    ds_write_b128 v239, v[120:123] offset:16896
    v_mfma_f32_32x32x16_bf16 v[148:163], v[216:219], v[16:19], v[148:163]
    s_add_u32 s97, s96, 15360
    buffer_store_dwordx4 v[116:119], v254, s[20:23], s97 offen
    buffer_store_dwordx4 v[120:123], v254, s[20:23], s97 offen offset:1024
    v_cvt_pk_bf16_f32 v124, v100, v101
    v_mfma_f32_32x32x16_bf16 v[148:163], v[220:223], v[20:23], v[148:163]
    v_cvt_pk_bf16_f32 v125, v102, v103
    v_cvt_pk_bf16_f32 v126, v104, v105
    v_cvt_pk_bf16_f32 v127, v106, v107
    v_mfma_f32_32x32x16_bf16 v[164:179], v[212:215], v[24:27], 0
    v_cvt_pk_bf16_f32 v128, v108, v109
    v_cvt_pk_bf16_f32 v129, v110, v111
    v_cvt_pk_bf16_f32 v130, v112, v113
    v_cvt_pk_bf16_f32 v131, v114, v115
    v_mfma_f32_32x32x16_bf16 v[164:179], v[216:219], v[28:31], v[164:179]
    s_nop 0
    v_permlane16_swap_b32 v124, v128
    v_permlane16_swap_b32 v125, v129
    v_mfma_f32_32x32x16_bf16 v[164:179], v[220:223], v[32:35], v[164:179]
    v_permlane16_swap_b32 v126, v130
    v_permlane16_swap_b32 v127, v131
    ds_write_b128 v234, v[124:127] offset:17920
    buffer_store_dwordx4 v[124:127], v235, s[20:23], s97 offen offset:2048
    v_mov_b32 v224, 0
    v_mov_b32 v225, 0
    v_mov_b32 v226, 0
    v_mov_b32 v227, 0
    s_nop 1
    v_mfma_f32_32x32x16_bf16 v[36:51], v[224:227], v[224:227], 0
    v_mfma_f32_32x32x16_bf16 v[52:67], v[224:227], v[224:227], 0
    v_mfma_f32_32x32x16_bf16 v[68:83], v[224:227], v[224:227], 0
    v_mfma_f32_32x32x16_bf16 v[84:99], v[224:227], v[224:227], 0
    v_mfma_f32_32x32x16_bf16 v[100:115], v[224:227], v[224:227], 0
    v_mfma_f32_32x32x16_bf16 v[116:131], v[224:227], v[224:227], 0
    v_lshrrev_b32 v248, 5, v247
    v_lshlrev_b32 v248, 2, v248
    v_bfe_u32 v249, v247, 2, 2
    v_add_u32 v248, v248, v249
    v_mul_u32_u24 v248, 192, v248
    v_bfe_u32 v249, v247, 4, 1
    v_lshlrev_b32 v249, 5, v249
    v_and_b32 v250, 3, v247
    v_lshlrev_b32 v250, 3, v250
    v_add3_u32 v248, v248, v249, v250
    s_mul_i32 s34, s27, 9216
    s_add_u32 s35, s34, 102400
    v_add_u32 v246, s35, v248
    s_sub_u32 s35, 111616, s34
    v_add_u32 v252, s35, v248
    v_bfe_u32 v248, v247, 3, 2
    v_mul_u32_u24 v248, 224, v248
    v_and_b32 v249, 7, v247
    v_add_u32 v248, v248, v249
    v_mul_u32_u24 v248, 192, v248
    v_lshrrev_b32 v249, 5, v247
    v_lshlrev_b32 v249, 4, v249
    v_add_u32 v253, v248, v249
    s_sub_u32 s89, 1, s98
    s_add_u32 s41, s48, s89
    s_add_u32 s34, s28, s41
    s_lshr_b32 s35, s34, 1
    s_and_b32 s36, s34, 1
    s_lshl_b32 s37, s24, 1
    s_add_u32 s36, s36, s37
    s_sub_u32 s37, s24, 28
    s_cmp_eq_u32 s27, 1
    s_cselect_b32 s35, s37, s35
    s_cselect_b32 s36, s34, s36
    s_mul_i32 s90, s36, 28
    s_add_u32 s90, s90, s35
    s_mul_i32 s91, s36, 896
    s_lshl_b32 s35, s35, 3
    s_add_u32 s91, s91, s35
    s_mul_i32 s91, s91, 192
    s_lshl_b32 s90, s90, 12
    s_add_u32 s90, s90, 19267584
    s_mov_b32 s8, s90
    s_mov_b32 s84, s91
    s_lshl_b32 s89, s98, 1
    s_add_u32 s41, s48, s89
    s_add_u32 s34, s28, s41
    s_lshr_b32 s35, s34, 1
    s_and_b32 s36, s34, 1
    s_lshl_b32 s37, s24, 1
    s_add_u32 s36, s36, s37
    s_sub_u32 s37, s24, 28
    s_cmp_eq_u32 s27, 1
    s_cselect_b32 s35, s37, s35
    s_cselect_b32 s36, s34, s36
    s_mul_i32 s90, s36, 28
    s_add_u32 s90, s90, s35
    s_mul_i32 s91, s36, 896
    s_lshl_b32 s35, s35, 3
    s_add_u32 s91, s91, s35
    s_mul_i32 s91, s91, 192
    s_lshl_b32 s90, s90, 12
    s_add_u32 s90, s90, 19267584
    s_mov_b32 s9, s90
    s_mov_b32 s85, s91
    s_sub_u32 s89, 2, s98
    s_add_u32 s41, s48, s89
    s_add_u32 s34, s28, s41
    s_lshr_b32 s35, s34, 1
    s_and_b32 s36, s34, 1
    s_lshl_b32 s37, s24, 1
    s_add_u32 s36, s36, s37
    s_sub_u32 s37, s24, 28
    s_cmp_eq_u32 s27, 1
    s_cselect_b32 s35, s37, s35
    s_cselect_b32 s36, s34, s36
    s_mul_i32 s90, s36, 28
    s_add_u32 s90, s90, s35
    s_mul_i32 s91, s36, 896
    s_lshl_b32 s35, s35, 3
    s_add_u32 s91, s91, s35
    s_mul_i32 s91, s91, 192
    s_lshl_b32 s90, s90, 12
    s_add_u32 s90, s90, 19267584
    s_mov_b32 s10, s90
    s_mov_b32 s86, s91
    v_max3_f32 v249, v132, v133, v134
    v_max3_f32 v249, v249, v135, v136
    v_max3_f32 v249, v249, v137, v138
    v_max3_f32 v249, v249, v139, v140
    v_max3_f32 v249, v249, v141, v142
    v_max3_f32 v249, v249, v143, v144
    v_max3_f32 v249, v249, v145, v146
    v_max_f32 v249, v249, v147
    v_mov_b32 v250, v249
    s_nop 1
    v_permlane32_swap_b32 v249, v250
    s_nop 1
    v_max_f32 v249, v249, v250
    v_sub_f32 v132, 0, v249
    v_sub_f32 v133, 0, v249
    v_sub_f32 v134, 0, v249
    v_sub_f32 v135, 0, v249
    v_sub_f32 v136, 0, v249
    v_sub_f32 v137, 0, v249
    v_sub_f32 v138, 0, v249
    v_sub_f32 v139, 0, v249
    v_sub_f32 v140, 0, v249
    v_sub_f32 v141, 0, v249
    v_sub_f32 v142, 0, v249
    v_sub_f32 v143, 0, v249
    v_sub_f32 v144, 0, v249
    v_sub_f32 v145, 0, v249
    v_sub_f32 v146, 0, v249
    v_sub_f32 v147, 0, v249
    v_max3_f32 v249, v148, v149, v150
    v_max3_f32 v249, v249, v151, v152
    v_max3_f32 v249, v249, v153, v154
    v_max3_f32 v249, v249, v155, v156
    v_max3_f32 v249, v249, v157, v158
    v_max3_f32 v249, v249, v159, v160
    v_max3_f32 v249, v249, v161, v162
    v_max_f32 v249, v249, v163
    v_mov_b32 v250, v249
    s_nop 1
    v_permlane32_swap_b32 v249, v250
    s_nop 1
    v_max_f32 v249, v249, v250
    v_sub_f32 v148, 0, v249
    v_sub_f32 v149, 0, v249
    v_sub_f32 v150, 0, v249
    v_sub_f32 v151, 0, v249
    v_sub_f32 v152, 0, v249
    v_sub_f32 v153, 0, v249
    v_sub_f32 v154, 0, v249
    v_sub_f32 v155, 0, v249
    v_sub_f32 v156, 0, v249
    v_sub_f32 v157, 0, v249
    v_sub_f32 v158, 0, v249
    v_sub_f32 v159, 0, v249
    v_sub_f32 v160, 0, v249
    v_sub_f32 v161, 0, v249
    v_sub_f32 v162, 0, v249
    v_sub_f32 v163, 0, v249
    v_max3_f32 v249, v164, v165, v166
    v_max3_f32 v249, v249, v167, v168
    v_max3_f32 v249, v249, v169, v170
    v_max3_f32 v249, v249, v171, v172
    v_max3_f32 v249, v249, v173, v174
    v_max3_f32 v249, v249, v175, v176
    v_max3_f32 v249, v249, v177, v178
    v_max_f32 v249, v249, v179
    v_mov_b32 v250, v249
    s_nop 1
    v_permlane32_swap_b32 v249, v250
    s_nop 1
    v_max_f32 v249, v249, v250
    v_sub_f32 v164, 0, v249
    v_sub_f32 v165, 0, v249
    v_sub_f32 v166, 0, v249
    v_sub_f32 v167, 0, v249
    v_sub_f32 v168, 0, v249
    v_sub_f32 v169, 0, v249
    v_sub_f32 v170, 0, v249
    v_sub_f32 v171, 0, v249
    v_sub_f32 v172, 0, v249
    v_sub_f32 v173, 0, v249
    v_sub_f32 v174, 0, v249
    v_sub_f32 v175, 0, v249
    v_sub_f32 v176, 0, v249
    v_sub_f32 v177, 0, v249
    v_sub_f32 v178, 0, v249
    v_sub_f32 v179, 0, v249
    v_mov_b32 v248, 4
    global_load_dword v245, v248, s[68:69] sc1
    s_waitcnt lgkmcnt(0)
    s_barrier
    s_branch L_Amain
L_xslow0:
    s_mov_b32 s37, 0
L_xs0:
    ds_read_b32 v249, v248
    s_waitcnt lgkmcnt(0)
    v_readfirstlane_b32 s34, v249
    s_cmp_eq_u32 s34, 1
    s_cbranch_scc1 L_xd0
    s_sleep 1
    s_add_u32 s37, s37, 1
    s_cmp_lt_u32 s37, 0x100000
    s_cbranch_scc1 L_xs0
    s_branch L_xd0
L_xslow1:
    s_mov_b32 s37, 0
L_xs1:
    ds_read_b32 v249, v248
    s_waitcnt lgkmcnt(0)
    v_readfirstlane_b32 s34, v249
    s_cmp_eq_u32 s34, 1
    s_cbranch_scc1 L_xd1
    s_sleep 1
    s_add_u32 s37, s37, 1
    s_cmp_lt_u32 s37, 0x100000
    s_cbranch_scc1 L_xs1
    s_branch L_xd1
L_xslow2:
    s_mov_b32 s37, 0
L_xs2:
    ds_read_b32 v249, v248
    s_waitcnt lgkmcnt(0)
    v_readfirstlane_b32 s34, v249
    s_cmp_eq_u32 s34, 1
    s_cbranch_scc1 L_xd2
    s_sleep 1
    s_add_u32 s37, s37, 1
    s_cmp_lt_u32 s37, 0x100000
    s_cbranch_scc1 L_xs2
    s_branch L_xd2
L_p1B:
    v_mov_b32 v248, 153632
    s_mov_b32 s37, 0
L_spwB:
    ds_read_b32 v249, v248
    s_waitcnt lgkmcnt(0)
    v_readfirstlane_b32 s34, v249
    s_cmp_eq_u32 s34, 8
    s_cbranch_scc1 L_spdwB
    s_sleep 1
    s_add_u32 s37, s37, 1
    s_cmp_lt_u32 s37, 0x100000
    s_cbranch_scc1 L_spwB
L_spdwB:
    s_lshl_b32 s35, s48, 2
    s_add_u32 s35, s35, 153664
    v_mov_b32 v248, s35
    s_mov_b32 s37, 0
L_spxB:
    ds_read_b32 v249, v248
    s_waitcnt lgkmcnt(0)
    v_readfirstlane_b32 s34, v249
    s_cmp_eq_u32 s34, 1
    s_cbranch_scc1 L_spdxB
    s_sleep 1
    s_add_u32 s37, s37, 1
    s_cmp_lt_u32 s37, 0x100000
    s_cbranch_scc1 L_spxB
L_spdxB:
    ds_read_b128 v[132:135], v245 offset:0
    ds_read_b128 v[136:139], v246 offset:0
    ds_read_b128 v[140:143], v245 offset:64
    ds_read_b128 v[144:147], v246 offset:64
    ds_read_b128 v[148:151], v245 offset:128
    ds_read_b128 v[152:155], v246 offset:128
    s_cmp_eq_u32 s30, 1
    s_cbranch_scc1 L_pp_v
    ds_read_b64_tr_b16 v[180:181], v252 offset:0
    ds_read_b64_tr_b16 v[182:183], v252 offset:1280
    ds_read_b64_tr_b16 v[184:185], v252 offset:64
    ds_read_b64_tr_b16 v[186:187], v252 offset:1344
    ds_read_b64_tr_b16 v[188:189], v252 offset:128
    ds_read_b64_tr_b16 v[190:191], v252 offset:1408
    ds_read_b64_tr_b16 v[192:193], v252 offset:5120
    ds_read_b64_tr_b16 v[194:195], v252 offset:6400
    ds_read_b64_tr_b16 v[196:197], v252 offset:5184
    ds_read_b64_tr_b16 v[198:199], v252 offset:6464
    ds_read_b64_tr_b16 v[200:201], v252 offset:5248
    ds_read_b64_tr_b16 v[202:203], v252 offset:6528
    ds_read_b64_tr_b16 v[204:205], v252 offset:10240
    ds_read_b64_tr_b16 v[206:207], v252 offset:11520
    s_waitcnt lgkmcnt(12)
    v_mfma_f32_32x32x16_bf16 v[68:83], v[180:183], v[132:135], 0
    ds_read_b64_tr_b16 v[208:209], v252 offset:10304
    ds_read_b64_tr_b16 v[210:211], v252 offset:11584
    s_waitcnt lgkmcnt(12)
    v_mfma_f32_32x32x16_bf16 v[84:99], v[184:187], v[132:135], 0
    ds_read_b64_tr_b16 v[180:181], v252 offset:10368
    ds_read_b64_tr_b16 v[182:183], v252 offset:11648
    s_waitcnt lgkmcnt(12)
    v_mfma_f32_32x32x16_bf16 v[100:115], v[188:191], v[132:135], 0
    ds_read_b64_tr_b16 v[184:185], v252 offset:15360
    ds_read_b64_tr_b16 v[186:187], v252 offset:16640
    s_waitcnt lgkmcnt(12)
    v_mfma_f32_32x32x16_bf16 v[68:83], v[192:195], v[136:139], v[68:83]
    ds_read_b64_tr_b16 v[188:189], v252 offset:15424
    ds_read_b64_tr_b16 v[190:191], v252 offset:16704
    s_waitcnt lgkmcnt(12)
    v_mfma_f32_32x32x16_bf16 v[84:99], v[196:199], v[136:139], v[84:99]
    ds_read_b64_tr_b16 v[192:193], v252 offset:15488
    ds_read_b64_tr_b16 v[194:195], v252 offset:16768
    s_waitcnt lgkmcnt(12)
    v_mfma_f32_32x32x16_bf16 v[100:115], v[200:203], v[136:139], v[100:115]
    ds_read_b64_tr_b16 v[196:197], v252 offset:20480
    ds_read_b64_tr_b16 v[198:199], v252 offset:21760
    s_waitcnt lgkmcnt(12)
    v_mfma_f32_32x32x16_bf16 v[68:83], v[204:207], v[140:143], v[68:83]
    ds_read_b64_tr_b16 v[200:201], v252 offset:20544
    ds_read_b64_tr_b16 v[202:203], v252 offset:21824
    s_waitcnt lgkmcnt(12)
    v_mfma_f32_32x32x16_bf16 v[84:99], v[208:211], v[140:143], v[84:99]
    ds_read_b64_tr_b16 v[204:205], v252 offset:20608
    ds_read_b64_tr_b16 v[206:207], v252 offset:21888
    s_waitcnt lgkmcnt(12)
    v_mfma_f32_32x32x16_bf16 v[100:115], v[180:183], v[140:143], v[100:115]
    ds_read_b64_tr_b16 v[208:209], v252 offset:25600
    ds_read_b64_tr_b16 v[210:211], v252 offset:26880
    s_waitcnt lgkmcnt(12)
    v_mfma_f32_32x32x16_bf16 v[68:83], v[184:187], v[144:147], v[68:83]
    ds_read_b64_tr_b16 v[180:181], v252 offset:25664
    ds_read_b64_tr_b16 v[182:183], v252 offset:26944
    s_waitcnt lgkmcnt(12)
    v_mfma_f32_32x32x16_bf16 v[84:99], v[188:191], v[144:147], v[84:99]
    ds_read_b64_tr_b16 v[184:185], v252 offset:25728
    ds_read_b64_tr_b16 v[186:187], v252 offset:27008
    s_waitcnt lgkmcnt(12)
    v_mfma_f32_32x32x16_bf16 v[100:115], v[192:195], v[144:147], v[100:115]
    s_waitcnt lgkmcnt(10)
    v_mfma_f32_32x32x16_bf16 v[68:83], v[196:199], v[148:151], v[68:83]
    s_waitcnt lgkmcnt(8)
    v_mfma_f32_32x32x16_bf16 v[84:99], v[200:203], v[148:151], v[84:99]
    s_waitcnt lgkmcnt(6)
    v_mfma_f32_32x32x16_bf16 v[100:115], v[204:207], v[148:151], v[100:115]
    s_waitcnt lgkmcnt(4)
    v_mfma_f32_32x32x16_bf16 v[68:83], v[208:211], v[152:155], v[68:83]
    s_waitcnt lgkmcnt(2)
    v_mfma_f32_32x32x16_bf16 v[84:99], v[180:183], v[152:155], v[84:99]
    s_waitcnt lgkmcnt(0)
    v_mfma_f32_32x32x16_bf16 v[100:115], v[184:187], v[152:155], v[100:115]
    s_nop 15
    v_pk_mul_f32 v[68:69], v[68:69], s[44:45]
    v_pk_mul_f32 v[70:71], v[70:71], s[44:45]
    v_pk_mul_f32 v[72:73], v[72:73], s[44:45]
    v_pk_mul_f32 v[74:75], v[74:75], s[44:45]
    v_pk_mul_f32 v[76:77], v[76:77], s[44:45]
    v_pk_mul_f32 v[78:79], v[78:79], s[44:45]
    v_pk_mul_f32 v[80:81], v[80:81], s[44:45]
    v_pk_mul_f32 v[82:83], v[82:83], s[44:45]
    v_pk_mul_f32 v[84:85], v[84:85], s[44:45]
    v_pk_mul_f32 v[86:87], v[86:87], s[44:45]
    v_pk_mul_f32 v[88:89], v[88:89], s[44:45]
    v_pk_mul_f32 v[90:91], v[90:91], s[44:45]
    v_cvt_pk_bf16_f32 v156, v68, v69
    v_cvt_pk_bf16_f32 v157, v70, v71
    v_cvt_pk_bf16_f32 v158, v72, v73
    v_cvt_pk_bf16_f32 v159, v74, v75
    v_cvt_pk_bf16_f32 v160, v76, v77
    v_cvt_pk_bf16_f32 v161, v78, v79
    v_cvt_pk_bf16_f32 v162, v80, v81
    v_cvt_pk_bf16_f32 v163, v82, v83
    v_cvt_pk_bf16_f32 v164, v84, v85
    v_cvt_pk_bf16_f32 v165, v86, v87
    v_cvt_pk_bf16_f32 v166, v88, v89
    v_cvt_pk_bf16_f32 v167, v90, v91
    v_cvt_pk_bf16_f32 v168, v92, v93
    v_cvt_pk_bf16_f32 v169, v94, v95
    v_cvt_pk_bf16_f32 v170, v96, v97
    v_cvt_pk_bf16_f32 v171, v98, v99
    v_cvt_pk_bf16_f32 v172, v100, v101
    v_cvt_pk_bf16_f32 v173, v102, v103
    v_cvt_pk_bf16_f32 v174, v104, v105
    v_cvt_pk_bf16_f32 v175, v106, v107
    v_cvt_pk_bf16_f32 v176, v108, v109
    v_cvt_pk_bf16_f32 v177, v110, v111
    v_cvt_pk_bf16_f32 v178, v112, v113
    v_cvt_pk_bf16_f32 v179, v114, v115
    s_sub_u32 s34, s48, 12
    s_mul_i32 s34, s34, 3072
    s_add_u32 s34, s34, 132608
    v_add_u32 v248, s34, v254
    ds_write_b128 v248, v[156:159] offset:0
    ds_write_b128 v248, v[160:163] offset:1024
    ds_write_b128 v248, v[164:167] offset:2048
    ds_write_b128 v236, v[168:171] offset:0
    ds_write_b128 v236, v[172:175] offset:1024
    ds_write_b128 v236, v[176:179] offset:2048
    buffer_store_dwordx4 v[168:171], v237, s[20:23], s96 offen offset:0
    buffer_store_dwordx4 v[172:175], v237, s[20:23], s96 offen offset:1024
    buffer_store_dwordx4 v[176:179], v237, s[20:23], s96 offen offset:2048
    s_branch L_pp_end
L_pp_v:
    ds_read_b64_tr_b16 v[180:181], v252 offset:192
    ds_read_b64_tr_b16 v[182:183], v252 offset:1472
    ds_read_b64_tr_b16 v[184:185], v252 offset:256
    ds_read_b64_tr_b16 v[186:187], v252 offset:1536
    ds_read_b64_tr_b16 v[188:189], v252 offset:5312
    ds_read_b64_tr_b16 v[190:191], v252 offset:6592
    ds_read_b64_tr_b16 v[192:193], v252 offset:5376
    ds_read_b64_tr_b16 v[194:195], v252 offset:6656
    ds_read_b64_tr_b16 v[196:197], v252 offset:10432
    ds_read_b64_tr_b16 v[198:199], v252 offset:11712
    ds_read_b64_tr_b16 v[200:201], v252 offset:10496
    ds_read_b64_tr_b16 v[202:203], v252 offset:11776
    ds_read_b64_tr_b16 v[204:205], v252 offset:15552
    ds_read_b64_tr_b16 v[206:207], v252 offset:16832
    s_waitcnt lgkmcnt(12)
    v_mfma_f32_32x32x16_bf16 v[68:83], v[132:135], v[180:183], 0
    ds_read_b64_tr_b16 v[208:209], v252 offset:15616
    ds_read_b64_tr_b16 v[210:211], v252 offset:16896
    s_waitcnt lgkmcnt(12)
    v_mfma_f32_32x32x16_bf16 v[84:99], v[132:135], v[184:187], 0
    ds_read_b64_tr_b16 v[180:181], v252 offset:20672
    ds_read_b64_tr_b16 v[182:183], v252 offset:21952
    s_waitcnt lgkmcnt(12)
    v_mfma_f32_32x32x16_bf16 v[68:83], v[136:139], v[188:191], v[68:83]
    ds_read_b64_tr_b16 v[184:185], v252 offset:20736
    ds_read_b64_tr_b16 v[186:187], v252 offset:22016
    s_waitcnt lgkmcnt(12)
    v_mfma_f32_32x32x16_bf16 v[84:99], v[136:139], v[192:195], v[84:99]
    ds_read_b64_tr_b16 v[188:189], v252 offset:25792
    ds_read_b64_tr_b16 v[190:191], v252 offset:27072
    s_waitcnt lgkmcnt(12)
    v_mfma_f32_32x32x16_bf16 v[68:83], v[140:143], v[196:199], v[68:83]
    ds_read_b64_tr_b16 v[192:193], v252 offset:25856
    ds_read_b64_tr_b16 v[194:195], v252 offset:27136
    s_waitcnt lgkmcnt(12)
    v_mfma_f32_32x32x16_bf16 v[84:99], v[140:143], v[200:203], v[84:99]
    s_waitcnt lgkmcnt(10)
    v_mfma_f32_32x32x16_bf16 v[68:83], v[144:147], v[204:207], v[68:83]
    s_waitcnt lgkmcnt(8)
    v_mfma_f32_32x32x16_bf16 v[84:99], v[144:147], v[208:211], v[84:99]
    s_waitcnt lgkmcnt(6)
    v_mfma_f32_32x32x16_bf16 v[68:83], v[148:151], v[180:183], v[68:83]
    s_waitcnt lgkmcnt(4)
    v_mfma_f32_32x32x16_bf16 v[84:99], v[148:151], v[184:187], v[84:99]
    s_waitcnt lgkmcnt(2)
    v_mfma_f32_32x32x16_bf16 v[68:83], v[152:155], v[188:191], v[68:83]
    s_waitcnt lgkmcnt(0)
    v_mfma_f32_32x32x16_bf16 v[84:99], v[152:155], v[192:195], v[84:99]
    s_nop 15
    v_cvt_pk_bf16_f32 v156, v68, v69
    v_cvt_pk_bf16_f32 v157, v70, v71
    v_cvt_pk_bf16_f32 v158, v72, v73
    v_cvt_pk_bf16_f32 v159, v74, v75
    v_cvt_pk_bf16_f32 v160, v76, v77
    v_cvt_pk_bf16_f32 v161, v78, v79
    v_cvt_pk_bf16_f32 v162, v80, v81
    v_cvt_pk_bf16_f32 v163, v82, v83
    v_cvt_pk_bf16_f32 v164, v84, v85
    v_cvt_pk_bf16_f32 v165, v86, v87
    v_cvt_pk_bf16_f32 v166, v88, v89
    v_cvt_pk_bf16_f32 v167, v90, v91
    v_cvt_pk_bf16_f32 v168, v92, v93
    v_cvt_pk_bf16_f32 v169, v94, v95
    v_cvt_pk_bf16_f32 v170, v96, v97
    v_cvt_pk_bf16_f32 v171, v98, v99
    ds_write_b128 v251, v[156:159] offset:3072
    ds_write_b128 v251, v[160:163] offset:4096
    s_add_u32 s97, s96, 3072
    buffer_store_dwordx4 v[156:159], v254, s[20:23], s97 offen
    buffer_store_dwordx4 v[160:163], v254, s[20:23], s97 offen offset:1024
    s_mov_b64 exec, s[46:47]
    ds_write_b128 v253, v[164:167] offset:5120
    ds_write_b128 v253, v[168:171] offset:5632
    buffer_store_dwordx4 v[164:167], v238, s[20:23], s97 offen offset:2048
    buffer_store_dwordx4 v[168:171], v238, s[20:23], s97 offen offset:2560
    s_mov_b64 exec, -1
L_pp_end:
    v_mov_b32 v224, 0
    v_mov_b32 v225, 0
    v_mov_b32 v226, 0
    v_mov_b32 v227, 0
    s_nop 1
    v_mfma_f32_32x32x16_bf16 v[36:51], v[224:227], v[224:227], 0
    v_mfma_f32_32x32x16_bf16 v[52:67], v[224:227], v[224:227], 0
    v_mfma_f32_32x32x16_bf16 v[68:83], v[224:227], v[224:227], 0
    v_mfma_f32_32x32x16_bf16 v[84:99], v[224:227], v[224:227], 0
    v_mfma_f32_32x32x16_bf16 v[100:115], v[224:227], v[224:227], 0
    v_mfma_f32_32x32x16_bf16 v[116:131], v[224:227], v[224:227], 0
    v_mov_b32 v240, 0xdddddddd
    s_mul_i32 s34, s30, 6400
    v_add_u32 v241, s34, v254
    v_add_u32 v242, s34, v254
    v_lshrrev_b32 v249, 5, v247
    v_lshlrev_b32 v249, 8, v249
    v_and_b32 v250, 15, v247
    v_lshlrev_b32 v251, 4, v250
    v_add_u32 v249, v249, v251
    v_add_u32 v251, -4, v250
    v_cmp_gt_u32 vcc, 8, v251
    v_mov_b32 v251, 1040
    v_mov_b32 v248, 1088
    v_cndmask_b32 v251, v251, v248, vcc
    v_cmp_eq_u32 vcc, 0, v250
    v_mov_b32 v248, 1024
    s_nop 0
    v_cndmask_b32 v251, v251, v248, vcc
    v_and_b32 v248, 16, v247
    v_cmp_eq_u32 vcc, 0, v248
    v_add_u32 v250, 512, v249
    s_nop 0
    v_cndmask_b32 v243, v251, v249, vcc
    v_cndmask_b32 v244, v251, v250, vcc
    v_add_u32 v243, s34, v243
    v_add_u32 v244, s34, v244
    v_lshrrev_b32 v248, 5, v247
    v_lshlrev_b32 v248, 2, v248
    v_bfe_u32 v249, v247, 2, 2
    v_add_u32 v248, v248, v249
    v_mul_u32_u24 v248, 192, v248
    v_bfe_u32 v249, v247, 4, 1
    v_lshlrev_b32 v249, 5, v249
    v_and_b32 v250, 3, v247
    v_lshlrev_b32 v250, 3, v250
    v_add3_u32 v248, v248, v249, v250
    s_mul_i32 s34, s27, 9216
    s_add_u32 s35, s34, 102400
    v_add_u32 v246, s35, v248
    s_sub_u32 s35, 111616, s34
    v_add_u32 v252, s35, v248
    v_bfe_u32 v248, v247, 3, 2
    v_mul_u32_u24 v248, 224, v248
    v_and_b32 v249, 7, v247
    v_add_u32 v248, v248, v249
    v_mul_u32_u24 v248, 192, v248
    v_lshrrev_b32 v249, 5, v247
    v_lshlrev_b32 v249, 4, v249
    v_add_u32 v253, v248, v249
    v_mov_b32 v248, 4
    global_load_dword v237, v248, s[68:69] sc1
    s_lshl_b32 s34, s24, 2
    s_add_u32 s34, s34, 32
    v_mov_b32 v249, s34
    global_load_dword v238, v249, s[68:69] sc1
L_cp_skip:
    s_waitcnt lgkmcnt(0)
    s_barrier
    s_sub_u32 s34, s48, 12
    s_mul_i32 s34, s34, 3072
    s_add_u32 s34, s34, 132608
    v_add_u32 v248, s34, v254
    ds_read_b128 v[0:3], v248 offset:0
    ds_read_b128 v[4:7], v248 offset:1024
    ds_read_b128 v[8:11], v248 offset:2048
    ds_read_b128 v[212:215], v254 offset:0
    ds_read_b128 v[216:219], v254 offset:1024
    ds_read_b128 v[220:223], v254 offset:2048
    s_waitcnt lgkmcnt(0)
    s_branch L_B
L_Amain:
    s_setprio 0
    s_mov_b32 s96, 0
    ds_read_b128 v[212:215], v241 offset:0
    ds_read_b128 v[216:219], v241 offset:1024
    ds_read_b128 v[220:223], v241 offset:2048
    ds_read_b128 v[224:227], v242 offset:3072
    ds_read_b128 v[228:231], v242 offset:4096
    ds_read_b128 v[232:235], v243 offset:5120
    ds_read_b128 v[236:239], v244 offset:5120
    s_waitcnt lgkmcnt(4)
    v_mfma_f32_32x32x16_bf16 v[180:195], v[212:215], v[0:3], v[132:147]
    v_mfma_f32_32x32x16_bf16 v[180:195], v[216:219], v[4:7], v[180:195]
    v_mfma_f32_32x32x16_bf16 v[180:195], v[220:223], v[8:11], v[180:195]
    s_nop 15
    v_exp_f32 v180, v180
    v_exp_f32 v181, v181
    v_exp_f32 v182, v182
    v_exp_f32 v183, v183
    v_exp_f32 v184, v184
    v_exp_f32 v185, v185
    s_waitcnt lgkmcnt(0)
    s_mov_b32 s31, 0
    s_mov_b32 s32, 0
.p2align 6
L_loopA:
    v_mfma_f32_32x32x16_bf16 v[196:211], v[212:215], v[12:15], v[148:163]
    s_cmp_eq_u32 s32, 2
    s_cselect_b32 s33, s39, s38
    v_exp_f32 v186, v186
    v_exp_f32 v187, v187
    v_exp_f32 v188, v188
    v_mfma_f32_32x32x16_bf16 v[196:211], v[216:219], v[16:19], v[196:211]
    v_exp_f32 v189, v189
    v_exp_f32 v190, v190
    v_mfma_f32_32x32x16_bf16 v[196:211], v[220:223], v[20:23], v[196:211]
    s_waitcnt lgkmcnt(0)
    v_exp_f32 v191, v191
    v_exp_f32 v192, v192
    v_exp_f32 v193, v193
    v_smfmac_f32_32x32x32_bf16 v[36:51], v[224:227], v[180:187], v240
    v_exp_f32 v194, v194
    v_exp_f32 v195, v195
    v_smfmac_f32_32x32x32_bf16 v[52:67], v[232:235], v[180:187], v240
    v_exp_f32 v196, v196
    v_exp_f32 v197, v197
    v_smfmac_f32_32x32x32_bf16 v[36:51], v[228:231], v[188:195], v240
    v_exp_f32 v198, v198
    v_exp_f32 v199, v199
    v_smfmac_f32_32x32x32_bf16 v[52:67], v[236:239], v[188:195], v240
    v_exp_f32 v200, v200
    v_exp_f32 v201, v201
    v_mfma_f32_32x32x16_bf16 v[180:195], v[212:215], v[24:27], v[164:179]
    v_exp_f32 v202, v202
    v_exp_f32 v203, v203
    v_exp_f32 v204, v204
    v_mfma_f32_32x32x16_bf16 v[180:195], v[216:219], v[28:31], v[180:195]
    ds_read_b128 v[212:215], v241 offset:6400
    ds_read_b128 v[216:219], v241 offset:7424
    v_exp_f32 v205, v205
    v_exp_f32 v206, v206
    v_mfma_f32_32x32x16_bf16 v[180:195], v[220:223], v[32:35], v[180:195]
    v_exp_f32 v207, v207
    v_exp_f32 v208, v208
    v_exp_f32 v209, v209
    v_smfmac_f32_32x32x32_bf16 v[68:83], v[224:227], v[196:203], v240
    ds_read_b128 v[220:223], v241 offset:8448
    v_exp_f32 v210, v210
    v_exp_f32 v211, v211
    v_smfmac_f32_32x32x32_bf16 v[84:99], v[232:235], v[196:203], v240
    v_exp_f32 v180, v180
    v_exp_f32 v181, v181
    v_smfmac_f32_32x32x32_bf16 v[68:83], v[228:231], v[204:211], v240
    v_exp_f32 v182, v182
    v_exp_f32 v183, v183
    v_smfmac_f32_32x32x32_bf16 v[84:99], v[236:239], v[204:211], v240
    s_waitcnt lgkmcnt(0)
    v_exp_f32 v184, v184
    v_exp_f32 v185, v185
    v_mfma_f32_32x32x16_bf16 v[196:211], v[212:215], v[0:3], v[132:147]
    v_exp_f32 v186, v186
    v_exp_f32 v187, v187
    v_exp_f32 v188, v188
    v_mfma_f32_32x32x16_bf16 v[196:211], v[216:219], v[4:7], v[196:211]
    v_exp_f32 v189, v189
    v_exp_f32 v190, v190
    v_mfma_f32_32x32x16_bf16 v[196:211], v[220:223], v[8:11], v[196:211]
    v_exp_f32 v191, v191
    v_exp_f32 v192, v192
    v_exp_f32 v193, v193
    v_smfmac_f32_32x32x32_bf16 v[100:115], v[224:227], v[180:187], v240
    ds_read_b128 v[224:227], v242 offset:9472
    v_exp_f32 v194, v194
    v_exp_f32 v195, v195
    v_smfmac_f32_32x32x32_bf16 v[116:131], v[232:235], v[180:187], v240
    ds_read_b128 v[232:235], v243 offset:11520
    v_exp_f32 v196, v196
    v_exp_f32 v197, v197
    v_smfmac_f32_32x32x32_bf16 v[100:115], v[228:231], v[188:195], v240
    ds_read_b128 v[228:231], v242 offset:10496
    v_exp_f32 v198, v198
    v_exp_f32 v199, v199
    v_smfmac_f32_32x32x32_bf16 v[116:131], v[236:239], v[188:195], v240
    ds_read_b128 v[236:239], v244 offset:11520
    v_exp_f32 v200, v200
    v_exp_f32 v201, v201
    v_mfma_f32_32x32x16_bf16 v[180:195], v[212:215], v[12:15], v[148:163]
    v_exp_f32 v202, v202
    v_exp_f32 v203, v203
    v_exp_f32 v204, v204
    v_mfma_f32_32x32x16_bf16 v[180:195], v[216:219], v[16:19], v[180:195]
    v_exp_f32 v205, v205
    v_exp_f32 v206, v206
    v_mfma_f32_32x32x16_bf16 v[180:195], v[220:223], v[20:23], v[180:195]
    s_waitcnt lgkmcnt(0)
    v_exp_f32 v207, v207
    v_exp_f32 v208, v208
    v_exp_f32 v209, v209
    v_smfmac_f32_32x32x32_bf16 v[36:51], v[224:227], v[196:203], v240
    v_exp_f32 v210, v210
    v_exp_f32 v211, v211
    v_smfmac_f32_32x32x32_bf16 v[52:67], v[232:235], v[196:203], v240
    v_exp_f32 v180, v180
    v_exp_f32 v181, v181
    v_smfmac_f32_32x32x32_bf16 v[36:51], v[228:231], v[204:211], v240
    v_exp_f32 v182, v182
    v_exp_f32 v183, v183
    v_smfmac_f32_32x32x32_bf16 v[52:67], v[236:239], v[204:211], v240
    v_exp_f32 v184, v184
    v_exp_f32 v185, v185
    v_mfma_f32_32x32x16_bf16 v[196:211], v[212:215], v[24:27], v[164:179]
    s_cmp_eq_u32 s31, 0
    s_cbranch_scc1 L_arrA
L_arrA_ret:
    v_exp_f32 v186, v186
    v_exp_f32 v187, v187
    v_exp_f32 v188, v188
    v_mfma_f32_32x32x16_bf16 v[196:211], v[216:219], v[28:31], v[196:211]
    ds_read_b128 v[212:215], v241 offset:12800
    ds_read_b128 v[216:219], v241 offset:13824
    v_exp_f32 v189, v189
    v_exp_f32 v190, v190
    v_mfma_f32_32x32x16_bf16 v[196:211], v[220:223], v[32:35], v[196:211]
    v_exp_f32 v191, v191
    v_exp_f32 v192, v192
    v_exp_f32 v193, v193
    v_smfmac_f32_32x32x32_bf16 v[68:83], v[224:227], v[180:187], v240
    ds_read_b128 v[220:223], v241 offset:14848
    v_exp_f32 v194, v194
    v_exp_f32 v195, v195
    v_smfmac_f32_32x32x32_bf16 v[84:99], v[232:235], v[180:187], v240
    v_exp_f32 v196, v196
    v_exp_f32 v197, v197
    v_smfmac_f32_32x32x32_bf16 v[68:83], v[228:231], v[188:195], v240
    v_exp_f32 v198, v198
    v_exp_f32 v199, v199
    v_smfmac_f32_32x32x32_bf16 v[84:99], v[236:239], v[188:195], v240
    s_waitcnt lgkmcnt(0)
    v_exp_f32 v200, v200
    v_exp_f32 v201, v201
    v_mfma_f32_32x32x16_bf16 v[180:195], v[212:215], v[0:3], v[132:147]
    v_exp_f32 v202, v202
    v_exp_f32 v203, v203
    v_exp_f32 v204, v204
    v_mfma_f32_32x32x16_bf16 v[180:195], v[216:219], v[4:7], v[180:195]
    v_exp_f32 v205, v205
    v_exp_f32 v206, v206
    v_mfma_f32_32x32x16_bf16 v[180:195], v[220:223], v[8:11], v[180:195]
    v_exp_f32 v207, v207
    v_exp_f32 v208, v208
    v_exp_f32 v209, v209
    v_smfmac_f32_32x32x32_bf16 v[100:115], v[224:227], v[196:203], v240
    ds_read_b128 v[224:227], v242 offset:15872
    v_exp_f32 v210, v210
    v_exp_f32 v211, v211
    v_smfmac_f32_32x32x32_bf16 v[116:131], v[232:235], v[196:203], v240
    ds_read_b128 v[232:235], v243 offset:17920
    v_exp_f32 v180, v180
    v_exp_f32 v181, v181
    v_smfmac_f32_32x32x32_bf16 v[100:115], v[228:231], v[204:211], v240
    ds_read_b128 v[228:231], v242 offset:16896
    v_exp_f32 v182, v182
    v_exp_f32 v183, v183
    v_smfmac_f32_32x32x32_bf16 v[116:131], v[236:239], v[204:211], v240
    ds_read_b128 v[236:239], v244 offset:17920
    v_exp_f32 v184, v184
    v_exp_f32 v185, v185
    v_mfma_f32_32x32x16_bf16 v[196:211], v[212:215], v[12:15], v[148:163]
    v_exp_f32 v186, v186
    v_exp_f32 v187, v187
    v_exp_f32 v188, v188
    v_mfma_f32_32x32x16_bf16 v[196:211], v[216:219], v[16:19], v[196:211]
    v_exp_f32 v189, v189
    v_exp_f32 v190, v190
    v_mfma_f32_32x32x16_bf16 v[196:211], v[220:223], v[20:23], v[196:211]
    s_waitcnt lgkmcnt(0)
    v_exp_f32 v191, v191
    v_exp_f32 v192, v192
    v_exp_f32 v193, v193
    v_smfmac_f32_32x32x32_bf16 v[36:51], v[224:227], v[180:187], v240
    v_exp_f32 v194, v194
    v_exp_f32 v195, v195
    v_smfmac_f32_32x32x32_bf16 v[52:67], v[232:235], v[180:187], v240
    v_exp_f32 v196, v196
    v_exp_f32 v197, v197
    v_smfmac_f32_32x32x32_bf16 v[36:51], v[228:231], v[188:195], v240
    v_exp_f32 v198, v198
    v_exp_f32 v199, v199
    v_smfmac_f32_32x32x32_bf16 v[52:67], v[236:239], v[188:195], v240
    v_exp_f32 v200, v200
    v_exp_f32 v201, v201
    v_mfma_f32_32x32x16_bf16 v[180:195], v[212:215], v[24:27], v[164:179]
    v_exp_f32 v202, v202
    v_exp_f32 v203, v203
    v_exp_f32 v204, v204
    v_mfma_f32_32x32x16_bf16 v[180:195], v[216:219], v[28:31], v[180:195]
    ds_read_b128 v[212:215], v241 offset:19200
    ds_read_b128 v[216:219], v241 offset:20224
    v_exp_f32 v205, v205
    v_exp_f32 v206, v206
    v_mfma_f32_32x32x16_bf16 v[180:195], v[220:223], v[32:35], v[180:195]
    v_exp_f32 v207, v207
    v_exp_f32 v208, v208
    v_exp_f32 v209, v209
    v_smfmac_f32_32x32x32_bf16 v[68:83], v[224:227], v[196:203], v240
    ds_read_b128 v[220:223], v241 offset:21248
    v_exp_f32 v210, v210
    v_exp_f32 v211, v211
    v_smfmac_f32_32x32x32_bf16 v[84:99], v[232:235], v[196:203], v240
    v_exp_f32 v180, v180
    v_exp_f32 v181, v181
    v_smfmac_f32_32x32x32_bf16 v[68:83], v[228:231], v[204:211], v240
    v_exp_f32 v182, v182
    v_exp_f32 v183, v183
    v_smfmac_f32_32x32x32_bf16 v[84:99], v[236:239], v[204:211], v240
    s_waitcnt lgkmcnt(0)
    v_exp_f32 v184, v184
    v_exp_f32 v185, v185
    v_mfma_f32_32x32x16_bf16 v[196:211], v[212:215], v[0:3], v[132:147]
    v_exp_f32 v186, v186
    v_exp_f32 v187, v187
    v_exp_f32 v188, v188
    v_mfma_f32_32x32x16_bf16 v[196:211], v[216:219], v[4:7], v[196:211]
    v_exp_f32 v189, v189
    v_exp_f32 v190, v190
    v_mfma_f32_32x32x16_bf16 v[196:211], v[220:223], v[8:11], v[196:211]
    v_exp_f32 v191, v191
    v_exp_f32 v192, v192
    v_exp_f32 v193, v193
    v_smfmac_f32_32x32x32_bf16 v[100:115], v[224:227], v[180:187], v240
    ds_read_b128 v[224:227], v242 offset:22272
    v_exp_f32 v194, v194
    v_exp_f32 v195, v195
    v_smfmac_f32_32x32x32_bf16 v[116:131], v[232:235], v[180:187], v240
    ds_read_b128 v[232:235], v243 offset:24320
    v_exp_f32 v196, v196
    v_exp_f32 v197, v197
    v_smfmac_f32_32x32x32_bf16 v[100:115], v[228:231], v[188:195], v240
    ds_read_b128 v[228:231], v242 offset:23296
    v_exp_f32 v198, v198
    v_exp_f32 v199, v199
    v_smfmac_f32_32x32x32_bf16 v[116:131], v[236:239], v[188:195], v240
    ds_read_b128 v[236:239], v244 offset:24320
    v_exp_f32 v200, v200
    v_exp_f32 v201, v201
    v_mfma_f32_32x32x16_bf16 v[180:195], v[212:215], v[12:15], v[148:163]
    v_exp_f32 v202, v202
    v_exp_f32 v203, v203
    v_exp_f32 v204, v204
    v_mfma_f32_32x32x16_bf16 v[180:195], v[216:219], v[16:19], v[180:195]
    v_exp_f32 v205, v205
    v_exp_f32 v206, v206
    v_mfma_f32_32x32x16_bf16 v[180:195], v[220:223], v[20:23], v[180:195]
    s_waitcnt lgkmcnt(0)
    v_exp_f32 v207, v207
    v_exp_f32 v208, v208
    v_exp_f32 v209, v209
    v_smfmac_f32_32x32x32_bf16 v[36:51], v[224:227], v[196:203], v240
    v_exp_f32 v210, v210
    v_exp_f32 v211, v211
    v_smfmac_f32_32x32x32_bf16 v[52:67], v[232:235], v[196:203], v240
    v_exp_f32 v180, v180
    v_exp_f32 v181, v181
    v_smfmac_f32_32x32x32_bf16 v[36:51], v[228:231], v[204:211], v240
    v_exp_f32 v182, v182
    v_exp_f32 v183, v183
    v_smfmac_f32_32x32x32_bf16 v[52:67], v[236:239], v[204:211], v240
    v_exp_f32 v184, v184
    v_exp_f32 v185, v185
    v_mfma_f32_32x32x16_bf16 v[196:211], v[212:215], v[24:27], v[164:179]
    v_exp_f32 v186, v186
    v_exp_f32 v187, v187
    v_exp_f32 v188, v188
    v_mfma_f32_32x32x16_bf16 v[196:211], v[216:219], v[28:31], v[196:211]
    ds_read_b128 v[212:215], v241 offset:25600
    ds_read_b128 v[216:219], v241 offset:26624
    v_exp_f32 v189, v189
    v_exp_f32 v190, v190
    v_mfma_f32_32x32x16_bf16 v[196:211], v[220:223], v[32:35], v[196:211]
    v_exp_f32 v191, v191
    v_exp_f32 v192, v192
    v_exp_f32 v193, v193
    v_smfmac_f32_32x32x32_bf16 v[68:83], v[224:227], v[180:187], v240
    ds_read_b128 v[220:223], v241 offset:27648
    v_exp_f32 v194, v194
    v_exp_f32 v195, v195
    v_smfmac_f32_32x32x32_bf16 v[84:99], v[232:235], v[180:187], v240
    v_exp_f32 v196, v196
    v_exp_f32 v197, v197
    v_smfmac_f32_32x32x32_bf16 v[68:83], v[228:231], v[188:195], v240
    v_exp_f32 v198, v198
    v_exp_f32 v199, v199
    v_smfmac_f32_32x32x32_bf16 v[84:99], v[236:239], v[188:195], v240
    s_waitcnt lgkmcnt(0)
    v_exp_f32 v200, v200
    v_exp_f32 v201, v201
    v_mfma_f32_32x32x16_bf16 v[180:195], v[212:215], v[0:3], v[132:147]
    v_exp_f32 v202, v202
    v_exp_f32 v203, v203
    v_exp_f32 v204, v204
    v_mfma_f32_32x32x16_bf16 v[180:195], v[216:219], v[4:7], v[180:195]
    v_exp_f32 v205, v205
    v_exp_f32 v206, v206
    v_mfma_f32_32x32x16_bf16 v[180:195], v[220:223], v[8:11], v[180:195]
    v_exp_f32 v207, v207
    v_exp_f32 v208, v208
    v_exp_f32 v209, v209
    v_smfmac_f32_32x32x32_bf16 v[100:115], v[224:227], v[196:203], v240
    ds_read_b128 v[224:227], v242 offset:28672
    v_exp_f32 v210, v210
    v_exp_f32 v211, v211
    v_smfmac_f32_32x32x32_bf16 v[116:131], v[232:235], v[196:203], v240
    ds_read_b128 v[232:235], v243 offset:30720
    v_exp_f32 v180, v180
    v_exp_f32 v181, v181
    v_smfmac_f32_32x32x32_bf16 v[100:115], v[228:231], v[204:211], v240
    ds_read_b128 v[228:231], v242 offset:29696
    v_exp_f32 v182, v182
    v_exp_f32 v183, v183
    v_smfmac_f32_32x32x32_bf16 v[116:131], v[236:239], v[204:211], v240
    ds_read_b128 v[236:239], v244 offset:30720
    v_exp_f32 v184, v184
    v_exp_f32 v185, v185
    v_mfma_f32_32x32x16_bf16 v[196:211], v[212:215], v[12:15], v[148:163]
    v_exp_f32 v186, v186
    v_exp_f32 v187, v187
    v_exp_f32 v188, v188
    v_mfma_f32_32x32x16_bf16 v[196:211], v[216:219], v[16:19], v[196:211]
    v_exp_f32 v189, v189
    v_exp_f32 v190, v190
    v_mfma_f32_32x32x16_bf16 v[196:211], v[220:223], v[20:23], v[196:211]
    s_waitcnt lgkmcnt(0)
    v_exp_f32 v191, v191
    v_exp_f32 v192, v192
    v_exp_f32 v193, v193
    v_smfmac_f32_32x32x32_bf16 v[36:51], v[224:227], v[180:187], v240
    v_exp_f32 v194, v194
    v_exp_f32 v195, v195
    v_smfmac_f32_32x32x32_bf16 v[52:67], v[232:235], v[180:187], v240
    v_exp_f32 v196, v196
    v_exp_f32 v197, v197
    v_smfmac_f32_32x32x32_bf16 v[36:51], v[228:231], v[188:195], v240
    v_exp_f32 v198, v198
    v_exp_f32 v199, v199
    v_smfmac_f32_32x32x32_bf16 v[52:67], v[236:239], v[188:195], v240
    v_exp_f32 v200, v200
    v_exp_f32 v201, v201
    v_mfma_f32_32x32x16_bf16 v[180:195], v[212:215], v[24:27], v[164:179]
    v_exp_f32 v202, v202
    v_exp_f32 v203, v203
    v_exp_f32 v204, v204
    v_mfma_f32_32x32x16_bf16 v[180:195], v[216:219], v[28:31], v[180:195]
    ds_read_b128 v[212:215], v241 offset:32000
    ds_read_b128 v[216:219], v241 offset:33024
    v_exp_f32 v205, v205
    v_exp_f32 v206, v206
    v_mfma_f32_32x32x16_bf16 v[180:195], v[220:223], v[32:35], v[180:195]
    v_exp_f32 v207, v207
    v_exp_f32 v208, v208
    v_exp_f32 v209, v209
    v_smfmac_f32_32x32x32_bf16 v[68:83], v[224:227], v[196:203], v240
    ds_read_b128 v[220:223], v241 offset:34048
    v_exp_f32 v210, v210
    v_exp_f32 v211, v211
    v_smfmac_f32_32x32x32_bf16 v[84:99], v[232:235], v[196:203], v240
    v_exp_f32 v180, v180
    v_exp_f32 v181, v181
    v_smfmac_f32_32x32x32_bf16 v[68:83], v[228:231], v[204:211], v240
    v_exp_f32 v182, v182
    v_exp_f32 v183, v183
    v_smfmac_f32_32x32x32_bf16 v[84:99], v[236:239], v[204:211], v240
    s_waitcnt lgkmcnt(0)
    v_exp_f32 v184, v184
    v_exp_f32 v185, v185
    v_mfma_f32_32x32x16_bf16 v[196:211], v[212:215], v[0:3], v[132:147]
    v_exp_f32 v186, v186
    v_exp_f32 v187, v187
    v_exp_f32 v188, v188
    v_mfma_f32_32x32x16_bf16 v[196:211], v[216:219], v[4:7], v[196:211]
    v_exp_f32 v189, v189
    v_exp_f32 v190, v190
    v_mfma_f32_32x32x16_bf16 v[196:211], v[220:223], v[8:11], v[196:211]
    v_exp_f32 v191, v191
    v_exp_f32 v192, v192
    v_exp_f32 v193, v193
    v_smfmac_f32_32x32x32_bf16 v[100:115], v[224:227], v[180:187], v240
    ds_read_b128 v[224:227], v242 offset:35072
    v_exp_f32 v194, v194
    v_exp_f32 v195, v195
    v_smfmac_f32_32x32x32_bf16 v[116:131], v[232:235], v[180:187], v240
    ds_read_b128 v[232:235], v243 offset:37120
    v_exp_f32 v196, v196
    v_exp_f32 v197, v197
    v_smfmac_f32_32x32x32_bf16 v[100:115], v[228:231], v[188:195], v240
    ds_read_b128 v[228:231], v242 offset:36096
    v_exp_f32 v198, v198
    v_exp_f32 v199, v199
    v_smfmac_f32_32x32x32_bf16 v[116:131], v[236:239], v[188:195], v240
    ds_read_b128 v[236:239], v244 offset:37120
    v_exp_f32 v200, v200
    v_exp_f32 v201, v201
    v_mfma_f32_32x32x16_bf16 v[180:195], v[212:215], v[12:15], v[148:163]
    v_exp_f32 v202, v202
    v_exp_f32 v203, v203
    v_exp_f32 v204, v204
    v_mfma_f32_32x32x16_bf16 v[180:195], v[216:219], v[16:19], v[180:195]
    v_exp_f32 v205, v205
    v_exp_f32 v206, v206
    v_mfma_f32_32x32x16_bf16 v[180:195], v[220:223], v[20:23], v[180:195]
    s_waitcnt lgkmcnt(0)
    v_exp_f32 v207, v207
    v_exp_f32 v208, v208
    v_exp_f32 v209, v209
    v_smfmac_f32_32x32x32_bf16 v[36:51], v[224:227], v[196:203], v240
    v_exp_f32 v210, v210
    v_exp_f32 v211, v211
    v_smfmac_f32_32x32x32_bf16 v[52:67], v[232:235], v[196:203], v240
    v_exp_f32 v180, v180
    v_exp_f32 v181, v181
    v_smfmac_f32_32x32x32_bf16 v[36:51], v[228:231], v[204:211], v240
    v_exp_f32 v182, v182
    v_exp_f32 v183, v183
    v_smfmac_f32_32x32x32_bf16 v[52:67], v[236:239], v[204:211], v240
    v_exp_f32 v184, v184
    v_exp_f32 v185, v185
    v_mfma_f32_32x32x16_bf16 v[196:211], v[212:215], v[24:27], v[164:179]
    s_cmp_eq_u32 s31, 1
    s_cbranch_scc1 L_midA
L_backA:
    v_exp_f32 v186, v186
    v_exp_f32 v187, v187
    v_exp_f32 v188, v188
    v_mfma_f32_32x32x16_bf16 v[196:211], v[216:219], v[28:31], v[196:211]
    ds_read_b128 v[212:215], v241 offset:38400
    ds_read_b128 v[216:219], v241 offset:39424
    v_exp_f32 v189, v189
    v_exp_f32 v190, v190
    v_mfma_f32_32x32x16_bf16 v[196:211], v[220:223], v[32:35], v[196:211]
    v_exp_f32 v191, v191
    v_exp_f32 v192, v192
    v_exp_f32 v193, v193
    v_smfmac_f32_32x32x32_bf16 v[68:83], v[224:227], v[180:187], v240
    ds_read_b128 v[220:223], v241 offset:40448
    v_exp_f32 v194, v194
    v_exp_f32 v195, v195
    v_smfmac_f32_32x32x32_bf16 v[84:99], v[232:235], v[180:187], v240
    v_exp_f32 v196, v196
    v_exp_f32 v197, v197
    v_smfmac_f32_32x32x32_bf16 v[68:83], v[228:231], v[188:195], v240
    v_exp_f32 v198, v198
    v_exp_f32 v199, v199
    v_smfmac_f32_32x32x32_bf16 v[84:99], v[236:239], v[188:195], v240
    s_waitcnt lgkmcnt(0)
    v_exp_f32 v200, v200
    v_exp_f32 v201, v201
    v_mfma_f32_32x32x16_bf16 v[180:195], v[212:215], v[0:3], v[132:147]
    v_exp_f32 v202, v202
    v_exp_f32 v203, v203
    v_exp_f32 v204, v204
    v_mfma_f32_32x32x16_bf16 v[180:195], v[216:219], v[4:7], v[180:195]
    v_exp_f32 v205, v205
    v_exp_f32 v206, v206
    v_mfma_f32_32x32x16_bf16 v[180:195], v[220:223], v[8:11], v[180:195]
    v_exp_f32 v207, v207
    v_exp_f32 v208, v208
    v_exp_f32 v209, v209
    v_smfmac_f32_32x32x32_bf16 v[100:115], v[224:227], v[196:203], v240
    ds_read_b128 v[224:227], v242 offset:41472
    v_exp_f32 v210, v210
    v_exp_f32 v211, v211
    v_smfmac_f32_32x32x32_bf16 v[116:131], v[232:235], v[196:203], v240
    ds_read_b128 v[232:235], v243 offset:43520
    v_exp_f32 v180, v180
    v_exp_f32 v181, v181
    v_smfmac_f32_32x32x32_bf16 v[100:115], v[228:231], v[204:211], v240
    ds_read_b128 v[228:231], v242 offset:42496
    v_exp_f32 v182, v182
    v_exp_f32 v183, v183
    v_smfmac_f32_32x32x32_bf16 v[116:131], v[236:239], v[204:211], v240
    ds_read_b128 v[236:239], v244 offset:43520
    v_exp_f32 v184, v184
    v_exp_f32 v185, v185
    v_mfma_f32_32x32x16_bf16 v[196:211], v[212:215], v[12:15], v[148:163]
    v_exp_f32 v186, v186
    v_exp_f32 v187, v187
    v_exp_f32 v188, v188
    v_mfma_f32_32x32x16_bf16 v[196:211], v[216:219], v[16:19], v[196:211]
    v_exp_f32 v189, v189
    v_exp_f32 v190, v190
    v_mfma_f32_32x32x16_bf16 v[196:211], v[220:223], v[20:23], v[196:211]
    s_waitcnt lgkmcnt(0)
    v_exp_f32 v191, v191
    v_exp_f32 v192, v192
    v_exp_f32 v193, v193
    v_smfmac_f32_32x32x32_bf16 v[36:51], v[224:227], v[180:187], v240
    v_exp_f32 v194, v194
    v_exp_f32 v195, v195
    v_smfmac_f32_32x32x32_bf16 v[52:67], v[232:235], v[180:187], v240
    v_exp_f32 v196, v196
    v_exp_f32 v197, v197
    v_smfmac_f32_32x32x32_bf16 v[36:51], v[228:231], v[188:195], v240
    v_exp_f32 v198, v198
    v_exp_f32 v199, v199
    v_smfmac_f32_32x32x32_bf16 v[52:67], v[236:239], v[188:195], v240
    v_exp_f32 v200, v200
    v_exp_f32 v201, v201
    v_mfma_f32_32x32x16_bf16 v[180:195], v[212:215], v[24:27], v[164:179]
    v_exp_f32 v202, v202
    v_exp_f32 v203, v203
    v_exp_f32 v204, v204
    v_mfma_f32_32x32x16_bf16 v[180:195], v[216:219], v[28:31], v[180:195]
    ds_read_b128 v[212:215], v241 offset:44800
    ds_read_b128 v[216:219], v241 offset:45824
    v_exp_f32 v205, v205
    v_exp_f32 v206, v206
    v_mfma_f32_32x32x16_bf16 v[180:195], v[220:223], v[32:35], v[180:195]
    v_exp_f32 v207, v207
    v_exp_f32 v208, v208
    v_exp_f32 v209, v209
    v_smfmac_f32_32x32x32_bf16 v[68:83], v[224:227], v[196:203], v240
    ds_read_b128 v[220:223], v241 offset:46848
    v_exp_f32 v210, v210
    v_exp_f32 v211, v211
    v_smfmac_f32_32x32x32_bf16 v[84:99], v[232:235], v[196:203], v240
    v_exp_f32 v180, v180
    v_exp_f32 v181, v181
    v_smfmac_f32_32x32x32_bf16 v[68:83], v[228:231], v[204:211], v240
    v_exp_f32 v182, v182
    v_exp_f32 v183, v183
    v_smfmac_f32_32x32x32_bf16 v[84:99], v[236:239], v[204:211], v240
    s_waitcnt lgkmcnt(0)
    v_exp_f32 v184, v184
    v_exp_f32 v185, v185
    v_mfma_f32_32x32x16_bf16 v[196:211], v[212:215], v[0:3], v[132:147]
    v_exp_f32 v186, v186
    v_exp_f32 v187, v187
    v_exp_f32 v188, v188
    v_mfma_f32_32x32x16_bf16 v[196:211], v[216:219], v[4:7], v[196:211]
    v_exp_f32 v189, v189
    v_exp_f32 v190, v190
    v_mfma_f32_32x32x16_bf16 v[196:211], v[220:223], v[8:11], v[196:211]
    v_exp_f32 v191, v191
    v_exp_f32 v192, v192
    v_exp_f32 v193, v193
    v_smfmac_f32_32x32x32_bf16 v[100:115], v[224:227], v[180:187], v240
    ds_read_b128 v[224:227], v242 offset:47872
    v_exp_f32 v194, v194
    v_exp_f32 v195, v195
    v_smfmac_f32_32x32x32_bf16 v[116:131], v[232:235], v[180:187], v240
    ds_read_b128 v[232:235], v243 offset:49920
    v_exp_f32 v196, v196
    v_exp_f32 v197, v197
    v_smfmac_f32_32x32x32_bf16 v[100:115], v[228:231], v[188:195], v240
    ds_read_b128 v[228:231], v242 offset:48896
    v_exp_f32 v198, v198
    v_exp_f32 v199, v199
    v_smfmac_f32_32x32x32_bf16 v[116:131], v[236:239], v[188:195], v240
    ds_read_b128 v[236:239], v244 offset:49920
    v_exp_f32 v200, v200
    v_exp_f32 v201, v201
    v_mfma_f32_32x32x16_bf16 v[180:195], v[212:215], v[12:15], v[148:163]
    v_exp_f32 v202, v202
    v_exp_f32 v203, v203
    v_exp_f32 v204, v204
    v_mfma_f32_32x32x16_bf16 v[180:195], v[216:219], v[16:19], v[180:195]
    v_exp_f32 v205, v205
    v_exp_f32 v206, v206
    v_mfma_f32_32x32x16_bf16 v[180:195], v[220:223], v[20:23], v[180:195]
    s_waitcnt lgkmcnt(0)
    v_exp_f32 v207, v207
    v_exp_f32 v208, v208
    v_exp_f32 v209, v209
    v_smfmac_f32_32x32x32_bf16 v[36:51], v[224:227], v[196:203], v240
    v_exp_f32 v210, v210
    v_exp_f32 v211, v211
    v_smfmac_f32_32x32x32_bf16 v[52:67], v[232:235], v[196:203], v240
    v_exp_f32 v180, v180
    v_exp_f32 v181, v181
    v_smfmac_f32_32x32x32_bf16 v[36:51], v[228:231], v[204:211], v240
    v_exp_f32 v182, v182
    v_exp_f32 v183, v183
    v_smfmac_f32_32x32x32_bf16 v[52:67], v[236:239], v[204:211], v240
    v_exp_f32 v184, v184
    v_exp_f32 v185, v185
    v_mfma_f32_32x32x16_bf16 v[196:211], v[212:215], v[24:27], v[164:179]
    v_exp_f32 v186, v186
    v_exp_f32 v187, v187
    v_exp_f32 v188, v188
    v_mfma_f32_32x32x16_bf16 v[196:211], v[216:219], v[28:31], v[196:211]
    v_add_u32 v241, s33, v241
    ds_read_b128 v[212:215], v241 offset:0
    ds_read_b128 v[216:219], v241 offset:1024
    v_exp_f32 v189, v189
    v_exp_f32 v190, v190
    v_mfma_f32_32x32x16_bf16 v[196:211], v[220:223], v[32:35], v[196:211]
    v_exp_f32 v191, v191
    v_exp_f32 v192, v192
    v_exp_f32 v193, v193
    v_smfmac_f32_32x32x32_bf16 v[68:83], v[224:227], v[180:187], v240
    ds_read_b128 v[220:223], v241 offset:2048
    v_exp_f32 v194, v194
    v_exp_f32 v195, v195
    v_smfmac_f32_32x32x32_bf16 v[84:99], v[232:235], v[180:187], v240
    v_exp_f32 v196, v196
    v_exp_f32 v197, v197
    v_smfmac_f32_32x32x32_bf16 v[68:83], v[228:231], v[188:195], v240
    v_exp_f32 v198, v198
    v_exp_f32 v199, v199
    v_smfmac_f32_32x32x32_bf16 v[84:99], v[236:239], v[188:195], v240
    s_waitcnt lgkmcnt(0)
    v_exp_f32 v200, v200
    v_exp_f32 v201, v201
    v_mfma_f32_32x32x16_bf16 v[180:195], v[212:215], v[0:3], v[132:147]
    v_exp_f32 v202, v202
    v_exp_f32 v203, v203
    v_exp_f32 v204, v204
    v_mfma_f32_32x32x16_bf16 v[180:195], v[216:219], v[4:7], v[180:195]
    v_add_u32 v242, s33, v242
    v_add_u32 v243, s33, v243
    v_add_u32 v244, s33, v244
    v_exp_f32 v205, v205
    v_exp_f32 v206, v206
    v_mfma_f32_32x32x16_bf16 v[180:195], v[220:223], v[8:11], v[180:195]
    v_exp_f32 v207, v207
    v_exp_f32 v208, v208
    v_exp_f32 v209, v209
    v_smfmac_f32_32x32x32_bf16 v[100:115], v[224:227], v[196:203], v240
    ds_read_b128 v[224:227], v242 offset:3072
    v_exp_f32 v210, v210
    v_exp_f32 v211, v211
    v_smfmac_f32_32x32x32_bf16 v[116:131], v[232:235], v[196:203], v240
    s_add_u32 s32, s32, 1
    s_cmp_eq_u32 s32, 3
    s_cselect_b32 s32, 0, s32
    s_add_u32 s31, s31, 1
    ds_read_b128 v[232:235], v243 offset:5120
    v_exp_f32 v180, v180
    v_exp_f32 v181, v181
    v_smfmac_f32_32x32x32_bf16 v[100:115], v[228:231], v[204:211], v240
    ds_read_b128 v[228:231], v242 offset:4096
    v_exp_f32 v182, v182
    v_exp_f32 v183, v183
    v_smfmac_f32_32x32x32_bf16 v[116:131], v[236:239], v[204:211], v240
    s_barrier
    s_cmp_lt_u32 s31, 6
    ds_read_b128 v[236:239], v244 offset:5120
    v_exp_f32 v184, v184
    v_exp_f32 v185, v185
    s_cbranch_scc1 L_loopA
    v_readfirstlane_b32 s92, v245
    ds_read_b128 v[212:215], v241 offset:6400
    ds_read_b128 v[216:219], v241 offset:7424
    ds_read_b128 v[220:223], v241 offset:8448
    s_cmp_lg_u32 s92, 0
    s_cbranch_scc1 L_f1
    s_mov_b32 s37, 0
L_gnf:
    v_mov_b32 v248, 4
    global_load_dword v249, v248, s[68:69] sc1
    s_waitcnt vmcnt(0)
    v_readfirstlane_b32 s92, v249
    s_cmp_lg_u32 s92, 0
    s_cbranch_scc1 L_gndf
    s_add_u32 s37, s37, 1
    s_cmp_lt_u32 s37, 0x40000
    s_cbranch_scc1 L_gnf
L_gndf:
L_f1:
    s_waitcnt lgkmcnt(0)
    v_mfma_f32_32x32x16_bf16 v[196:211], v[212:215], v[0:3], v[132:147]
    s_cmp_eq_u32 s32, 2
    s_cselect_b32 s33, s39, s38
    v_exp_f32 v186, v186
    v_exp_f32 v187, v187
    v_exp_f32 v188, v188
    v_mfma_f32_32x32x16_bf16 v[196:211], v[216:219], v[4:7], v[196:211]
    ds_read_b128 v[212:215], v241 offset:12800
    ds_read_b128 v[216:219], v241 offset:13824
    v_exp_f32 v189, v189
    v_exp_f32 v190, v190
    v_mfma_f32_32x32x16_bf16 v[196:211], v[220:223], v[8:11], v[196:211]
    s_waitcnt lgkmcnt(2)
    v_exp_f32 v191, v191
    v_exp_f32 v192, v192
    v_exp_f32 v193, v193
    v_smfmac_f32_32x32x32_bf16 v[36:51], v[224:227], v[180:187], v240
    ds_read_b128 v[220:223], v241 offset:14848
    ds_read_b128 v[224:227], v242 offset:9472
    v_exp_f32 v194, v194
    v_exp_f32 v195, v195
    v_smfmac_f32_32x32x32_bf16 v[52:67], v[232:235], v[180:187], v240
    ds_read_b128 v[232:235], v243 offset:11520
    v_exp_f32 v196, v196
    v_exp_f32 v197, v197
    v_smfmac_f32_32x32x32_bf16 v[36:51], v[228:231], v[188:195], v240
    ds_read_b128 v[228:231], v242 offset:10496
    v_exp_f32 v198, v198
    v_exp_f32 v199, v199
    v_smfmac_f32_32x32x32_bf16 v[52:67], v[236:239], v[188:195], v240
    s_waitcnt lgkmcnt(3)
    ds_read_b128 v[236:239], v244 offset:11520
    v_exp_f32 v200, v200
    v_exp_f32 v201, v201
    v_mfma_f32_32x32x16_bf16 v[180:195], v[212:215], v[0:3], v[132:147]
    v_exp_f32 v202, v202
    v_exp_f32 v203, v203
    v_exp_f32 v204, v204
    v_mfma_f32_32x32x16_bf16 v[180:195], v[216:219], v[4:7], v[180:195]
    ds_read_b128 v[212:215], v241 offset:19200
    ds_read_b128 v[216:219], v241 offset:20224
    v_exp_f32 v205, v205
    v_exp_f32 v206, v206
    v_mfma_f32_32x32x16_bf16 v[180:195], v[220:223], v[8:11], v[180:195]
    s_waitcnt lgkmcnt(2)
    v_exp_f32 v207, v207
    v_exp_f32 v208, v208
    v_exp_f32 v209, v209
    v_smfmac_f32_32x32x32_bf16 v[36:51], v[224:227], v[196:203], v240
    ds_read_b128 v[220:223], v241 offset:21248
    ds_read_b128 v[224:227], v242 offset:15872
    v_exp_f32 v210, v210
    v_exp_f32 v211, v211
    v_smfmac_f32_32x32x32_bf16 v[52:67], v[232:235], v[196:203], v240
    ds_read_b128 v[232:235], v243 offset:17920
    v_exp_f32 v180, v180
    v_exp_f32 v181, v181
    v_smfmac_f32_32x32x32_bf16 v[36:51], v[228:231], v[204:211], v240
    ds_read_b128 v[228:231], v242 offset:16896
    v_exp_f32 v182, v182
    v_exp_f32 v183, v183
    v_smfmac_f32_32x32x32_bf16 v[52:67], v[236:239], v[204:211], v240
    s_waitcnt lgkmcnt(3)
    ds_read_b128 v[236:239], v244 offset:17920
    v_exp_f32 v184, v184
    v_exp_f32 v185, v185
    v_mfma_f32_32x32x16_bf16 v[196:211], v[212:215], v[0:3], v[132:147]
    v_exp_f32 v186, v186
    v_exp_f32 v187, v187
    v_exp_f32 v188, v188
    v_mfma_f32_32x32x16_bf16 v[196:211], v[216:219], v[4:7], v[196:211]
    ds_read_b128 v[212:215], v241 offset:25600
    ds_read_b128 v[216:219], v241 offset:26624
    v_exp_f32 v189, v189
    v_exp_f32 v190, v190
    v_mfma_f32_32x32x16_bf16 v[196:211], v[220:223], v[8:11], v[196:211]
    s_waitcnt lgkmcnt(2)
    v_exp_f32 v191, v191
    v_exp_f32 v192, v192
    v_exp_f32 v193, v193
    v_smfmac_f32_32x32x32_bf16 v[36:51], v[224:227], v[180:187], v240
    ds_read_b128 v[220:223], v241 offset:27648
    ds_read_b128 v[224:227], v242 offset:22272
    v_exp_f32 v194, v194
    v_exp_f32 v195, v195
    v_smfmac_f32_32x32x32_bf16 v[52:67], v[232:235], v[180:187], v240
    ds_read_b128 v[232:235], v243 offset:24320
    v_exp_f32 v196, v196
    v_exp_f32 v197, v197
    v_smfmac_f32_32x32x32_bf16 v[36:51], v[228:231], v[188:195], v240
    ds_read_b128 v[228:231], v242 offset:23296
    v_exp_f32 v198, v198
    v_exp_f32 v199, v199
    v_smfmac_f32_32x32x32_bf16 v[52:67], v[236:239], v[188:195], v240
    s_waitcnt lgkmcnt(3)
    ds_read_b128 v[236:239], v244 offset:24320
    v_exp_f32 v200, v200
    v_exp_f32 v201, v201
    v_mfma_f32_32x32x16_bf16 v[180:195], v[212:215], v[0:3], v[132:147]
    v_exp_f32 v202, v202
    v_exp_f32 v203, v203
    v_exp_f32 v204, v204
    v_mfma_f32_32x32x16_bf16 v[180:195], v[216:219], v[4:7], v[180:195]
    ds_read_b128 v[212:215], v241 offset:32000
    ds_read_b128 v[216:219], v241 offset:33024
    v_exp_f32 v205, v205
    v_exp_f32 v206, v206
    v_mfma_f32_32x32x16_bf16 v[180:195], v[220:223], v[8:11], v[180:195]
    s_waitcnt lgkmcnt(2)
    v_exp_f32 v207, v207
    v_exp_f32 v208, v208
    v_exp_f32 v209, v209
    v_smfmac_f32_32x32x32_bf16 v[36:51], v[224:227], v[196:203], v240
    ds_read_b128 v[220:223], v241 offset:34048
    ds_read_b128 v[224:227], v242 offset:28672
    v_exp_f32 v210, v210
    v_exp_f32 v211, v211
    v_smfmac_f32_32x32x32_bf16 v[52:67], v[232:235], v[196:203], v240
    ds_read_b128 v[232:235], v243 offset:30720
    v_exp_f32 v180, v180
    v_exp_f32 v181, v181
    v_smfmac_f32_32x32x32_bf16 v[36:51], v[228:231], v[204:211], v240
    ds_read_b128 v[228:231], v242 offset:29696
    v_exp_f32 v182, v182
    v_exp_f32 v183, v183
    v_smfmac_f32_32x32x32_bf16 v[52:67], v[236:239], v[204:211], v240
    s_waitcnt lgkmcnt(3)
    ds_read_b128 v[236:239], v244 offset:30720
    v_exp_f32 v184, v184
    v_exp_f32 v185, v185
    v_mfma_f32_32x32x16_bf16 v[196:211], v[212:215], v[0:3], v[132:147]
    v_exp_f32 v186, v186
    v_exp_f32 v187, v187
    v_exp_f32 v188, v188
    v_mfma_f32_32x32x16_bf16 v[196:211], v[216:219], v[4:7], v[196:211]
    ds_read_b128 v[212:215], v241 offset:38400
    ds_read_b128 v[216:219], v241 offset:39424
    v_exp_f32 v189, v189
    v_exp_f32 v190, v190
    v_mfma_f32_32x32x16_bf16 v[196:211], v[220:223], v[8:11], v[196:211]
    s_waitcnt lgkmcnt(2)
    v_exp_f32 v191, v191
    v_exp_f32 v192, v192
    v_exp_f32 v193, v193
    v_smfmac_f32_32x32x32_bf16 v[36:51], v[224:227], v[180:187], v240
    ds_read_b128 v[220:223], v241 offset:40448
    ds_read_b128 v[224:227], v242 offset:35072
    v_exp_f32 v194, v194
    v_exp_f32 v195, v195
    v_smfmac_f32_32x32x32_bf16 v[52:67], v[232:235], v[180:187], v240
    ds_read_b128 v[232:235], v243 offset:37120
    v_exp_f32 v196, v196
    v_exp_f32 v197, v197
    v_smfmac_f32_32x32x32_bf16 v[36:51], v[228:231], v[188:195], v240
    ds_read_b128 v[228:231], v242 offset:36096
    v_exp_f32 v198, v198
    v_exp_f32 v199, v199
    v_smfmac_f32_32x32x32_bf16 v[52:67], v[236:239], v[188:195], v240
    s_waitcnt lgkmcnt(3)
    ds_read_b128 v[236:239], v244 offset:37120
    v_exp_f32 v200, v200
    v_exp_f32 v201, v201
    v_mfma_f32_32x32x16_bf16 v[180:195], v[212:215], v[0:3], v[132:147]
    v_exp_f32 v202, v202
    v_exp_f32 v203, v203
    v_exp_f32 v204, v204
    v_mfma_f32_32x32x16_bf16 v[180:195], v[216:219], v[4:7], v[180:195]
    ds_read_b128 v[212:215], v241 offset:44800
    ds_read_b128 v[216:219], v241 offset:45824
    v_exp_f32 v205, v205
    v_exp_f32 v206, v206
    v_mfma_f32_32x32x16_bf16 v[180:195], v[220:223], v[8:11], v[180:195]
    s_waitcnt lgkmcnt(2)
    v_exp_f32 v207, v207
    v_exp_f32 v208, v208
    v_exp_f32 v209, v209
    v_smfmac_f32_32x32x32_bf16 v[36:51], v[224:227], v[196:203], v240
    ds_read_b128 v[220:223], v241 offset:46848
    ds_read_b128 v[224:227], v242 offset:41472
    v_exp_f32 v210, v210
    v_exp_f32 v211, v211
    v_smfmac_f32_32x32x32_bf16 v[52:67], v[232:235], v[196:203], v240
    ds_read_b128 v[232:235], v243 offset:43520
    v_exp_f32 v180, v180
    v_exp_f32 v181, v181
    v_smfmac_f32_32x32x32_bf16 v[36:51], v[228:231], v[204:211], v240
    ds_read_b128 v[228:231], v242 offset:42496
    v_exp_f32 v182, v182
    v_exp_f32 v183, v183
    v_smfmac_f32_32x32x32_bf16 v[52:67], v[236:239], v[204:211], v240
    s_waitcnt lgkmcnt(3)
    ds_read_b128 v[236:239], v244 offset:43520
    v_exp_f32 v184, v184
    v_exp_f32 v185, v185
    v_mfma_f32_32x32x16_bf16 v[196:211], v[212:215], v[0:3], v[132:147]
    v_exp_f32 v186, v186
    v_exp_f32 v187, v187
    v_exp_f32 v188, v188
    v_mfma_f32_32x32x16_bf16 v[196:211], v[216:219], v[4:7], v[196:211]
    ds_read_b128 v[212:215], v241 offset:0
    ds_read_b128 v[216:219], v241 offset:1024
    v_exp_f32 v189, v189
    v_exp_f32 v190, v190
    v_mfma_f32_32x32x16_bf16 v[196:211], v[220:223], v[8:11], v[196:211]
    s_waitcnt lgkmcnt(2)
    v_exp_f32 v191, v191
    v_exp_f32 v192, v192
    v_exp_f32 v193, v193
    v_smfmac_f32_32x32x32_bf16 v[36:51], v[224:227], v[180:187], v240
    ds_read_b128 v[220:223], v241 offset:2048
    ds_read_b128 v[224:227], v242 offset:47872
    v_exp_f32 v194, v194
    v_exp_f32 v195, v195
    v_smfmac_f32_32x32x32_bf16 v[52:67], v[232:235], v[180:187], v240
    ds_read_b128 v[232:235], v243 offset:49920
    v_exp_f32 v196, v196
    v_exp_f32 v197, v197
    v_smfmac_f32_32x32x32_bf16 v[36:51], v[228:231], v[188:195], v240
    ds_read_b128 v[228:231], v242 offset:48896
    v_exp_f32 v198, v198
    v_exp_f32 v199, v199
    v_smfmac_f32_32x32x32_bf16 v[52:67], v[236:239], v[188:195], v240
    s_waitcnt lgkmcnt(3)
    ds_read_b128 v[236:239], v244 offset:49920
    v_exp_f32 v200, v200
    v_exp_f32 v201, v201
    v_mfma_f32_32x32x16_bf16 v[180:195], v[212:215], v[12:15], v[148:163]
    v_exp_f32 v202, v202
    v_exp_f32 v203, v203
    v_exp_f32 v204, v204
    v_mfma_f32_32x32x16_bf16 v[180:195], v[216:219], v[16:19], v[180:195]
    ds_read_b128 v[212:215], v241 offset:6400
    ds_read_b128 v[216:219], v241 offset:7424
    v_exp_f32 v205, v205
    v_exp_f32 v206, v206
    v_mfma_f32_32x32x16_bf16 v[180:195], v[220:223], v[20:23], v[180:195]
    s_waitcnt lgkmcnt(2)
    v_exp_f32 v207, v207
    v_exp_f32 v208, v208
    v_exp_f32 v209, v209
    v_smfmac_f32_32x32x32_bf16 v[36:51], v[224:227], v[196:203], v240
    ds_read_b128 v[220:223], v241 offset:8448
    ds_read_b128 v[224:227], v242 offset:3072
    v_exp_f32 v210, v210
    v_exp_f32 v211, v211
    v_smfmac_f32_32x32x32_bf16 v[52:67], v[232:235], v[196:203], v240
    ds_read_b128 v[232:235], v243 offset:5120
    v_exp_f32 v180, v180
    v_exp_f32 v181, v181
    v_smfmac_f32_32x32x32_bf16 v[36:51], v[228:231], v[204:211], v240
    ds_read_b128 v[228:231], v242 offset:4096
    v_exp_f32 v182, v182
    v_exp_f32 v183, v183
    v_smfmac_f32_32x32x32_bf16 v[52:67], v[236:239], v[204:211], v240
    s_waitcnt lgkmcnt(3)
    ds_read_b128 v[236:239], v244 offset:5120
    v_exp_f32 v184, v184
    v_exp_f32 v185, v185
    v_mfma_f32_32x32x16_bf16 v[196:211], v[212:215], v[12:15], v[148:163]
    v_exp_f32 v186, v186
    v_exp_f32 v187, v187
    v_exp_f32 v188, v188
    v_mfma_f32_32x32x16_bf16 v[196:211], v[216:219], v[16:19], v[196:211]
    ds_read_b128 v[212:215], v241 offset:12800
    ds_read_b128 v[216:219], v241 offset:13824
    v_exp_f32 v189, v189
    v_exp_f32 v190, v190
    v_mfma_f32_32x32x16_bf16 v[196:211], v[220:223], v[20:23], v[196:211]
    s_waitcnt lgkmcnt(2)
    v_exp_f32 v191, v191
    v_exp_f32 v192, v192
    v_exp_f32 v193, v193
    v_smfmac_f32_32x32x32_bf16 v[68:83], v[224:227], v[180:187], v240
    ds_read_b128 v[220:223], v241 offset:14848
    ds_read_b128 v[224:227], v242 offset:9472
    v_exp_f32 v194, v194
    v_exp_f32 v195, v195
    v_smfmac_f32_32x32x32_bf16 v[84:99], v[232:235], v[180:187], v240
    v_mov_b32 v250, v60
    v_mov_b32 v248, 0
    v_mov_b32 v249, 0
    v_permlane32_swap_b32 v60, v250
    v_pk_fma_f32 v[248:249], v[36:37], 0, v[248:249] op_sel_hi:[1,0,1]
    v_pk_fma_f32 v[248:249], v[38:39], 0, v[248:249] op_sel_hi:[1,0,1]
    v_pk_fma_f32 v[248:249], v[40:41], 0, v[248:249] op_sel_hi:[1,0,1]
    v_pk_fma_f32 v[248:249], v[42:43], 0, v[248:249] op_sel_hi:[1,0,1]
    v_pk_fma_f32 v[248:249], v[44:45], 0, v[248:249] op_sel_hi:[1,0,1]
    v_pk_fma_f32 v[248:249], v[46:47], 0, v[248:249] op_sel_hi:[1,0,1]
    v_pk_fma_f32 v[248:249], v[48:49], 0, v[248:249] op_sel_hi:[1,0,1]
    v_pk_fma_f32 v[248:249], v[50:51], 0, v[248:249] op_sel_hi:[1,0,1]
    v_pk_fma_f32 v[248:249], v[52:53], 0, v[248:249] op_sel_hi:[1,0,1]
    v_pk_fma_f32 v[248:249], v[54:55], 0, v[248:249] op_sel_hi:[1,0,1]
    v_pk_fma_f32 v[248:249], v[56:57], 0, v[248:249] op_sel_hi:[1,0,1]
    v_pk_fma_f32 v[248:249], v[58:59], 0, v[248:249] op_sel_hi:[1,0,1]
    v_cmp_gt_f32 vcc, 0x71800000, v60
    v_add_f32 v248, v248, v249
    s_mov_b64 s[6:7], vcc
    v_cmp_o_f32 vcc, v248, v248
    s_nop 0
    s_and_b64 vcc, vcc, s[6:7]
    s_cmp_eq_u64 vcc, -1
    s_cbranch_scc0 L_f0fail
    s_mov_b32 s90, s8
    s_mov_b32 s91, s84
    v_mov_b32 v135, s92
    v_mov_b32 v139, s92
    v_mov_b32 v143, s92
    v_mov_b32 v147, s92
    v_mov_b32 v250, v60
    s_nop 1
    v_permlane32_swap_b32 v60, v250
    s_nop 1
    v_rcp_f32 v248, v60
    s_nop 0
    v_pk_mul_f32 v[36:37], v[36:37], v[248:249] op_sel_hi:[1,0]
    v_pk_mul_f32 v[38:39], v[38:39], v[248:249] op_sel_hi:[1,0]
    v_pk_mul_f32 v[40:41], v[40:41], v[248:249] op_sel_hi:[1,0]
    v_pk_mul_f32 v[42:43], v[42:43], v[248:249] op_sel_hi:[1,0]
    v_pk_mul_f32 v[44:45], v[44:45], v[248:249] op_sel_hi:[1,0]
    v_pk_mul_f32 v[46:47], v[46:47], v[248:249] op_sel_hi:[1,0]
    v_pk_mul_f32 v[48:49], v[48:49], v[248:249] op_sel_hi:[1,0]
    v_pk_mul_f32 v[50:51], v[50:51], v[248:249] op_sel_hi:[1,0]
    v_pk_mul_f32 v[52:53], v[52:53], v[248:249] op_sel_hi:[1,0]
    v_pk_mul_f32 v[54:55], v[54:55], v[248:249] op_sel_hi:[1,0]
    v_pk_mul_f32 v[56:57], v[56:57], v[248:249] op_sel_hi:[1,0]
    v_pk_mul_f32 v[58:59], v[58:59], v[248:249] op_sel_hi:[1,0]
    v_cvt_pk_bf16_f32 v132, v36, v37
    v_cvt_pk_bf16_f32 v133, v38, v39
    v_cvt_pk_bf16_f32 v134, v40, v41
    v_cvt_pk_bf16_f32 v136, v42, v43
    v_cvt_pk_bf16_f32 v137, v44, v45
    v_cvt_pk_bf16_f32 v138, v46, v47
    v_cvt_pk_bf16_f32 v140, v48, v49
    v_cvt_pk_bf16_f32 v141, v50, v51
    v_cvt_pk_bf16_f32 v142, v52, v53
    v_cvt_pk_bf16_f32 v144, v54, v55
    v_cvt_pk_bf16_f32 v145, v56, v57
    v_cvt_pk_bf16_f32 v146, v58, v59
    buffer_store_dwordx4 v[132:135], v254, s[20:23], s90 offen offset:0 sc1
    buffer_store_dwordx4 v[136:139], v254, s[20:23], s90 offen offset:1024 sc1
    buffer_store_dwordx4 v[140:143], v254, s[20:23], s90 offen offset:2048 sc1
    buffer_store_dwordx4 v[144:147], v254, s[20:23], s90 offen offset:3072 sc1
L_f0done:
    ds_read_b128 v[232:235], v243 offset:11520
    v_exp_f32 v196, v196
    v_exp_f32 v197, v197
    v_smfmac_f32_32x32x32_bf16 v[68:83], v[228:231], v[188:195], v240
    ds_read_b128 v[228:231], v242 offset:10496
    v_exp_f32 v198, v198
    v_exp_f32 v199, v199
    v_smfmac_f32_32x32x32_bf16 v[84:99], v[236:239], v[188:195], v240
    s_waitcnt lgkmcnt(3)
    ds_read_b128 v[236:239], v244 offset:11520
    v_exp_f32 v200, v200
    v_exp_f32 v201, v201
    v_mfma_f32_32x32x16_bf16 v[180:195], v[212:215], v[12:15], v[148:163]
    v_exp_f32 v202, v202
    v_exp_f32 v203, v203
    v_exp_f32 v204, v204
    v_mfma_f32_32x32x16_bf16 v[180:195], v[216:219], v[16:19], v[180:195]
    ds_read_b128 v[212:215], v241 offset:19200
    ds_read_b128 v[216:219], v241 offset:20224
    v_exp_f32 v205, v205
    v_exp_f32 v206, v206
    v_mfma_f32_32x32x16_bf16 v[180:195], v[220:223], v[20:23], v[180:195]
    s_waitcnt lgkmcnt(2)
    v_exp_f32 v207, v207
    v_exp_f32 v208, v208
    v_exp_f32 v209, v209
    v_smfmac_f32_32x32x32_bf16 v[68:83], v[224:227], v[196:203], v240
    ds_read_b128 v[220:223], v241 offset:21248
    ds_read_b128 v[224:227], v242 offset:15872
    v_exp_f32 v210, v210
    v_exp_f32 v211, v211
    v_smfmac_f32_32x32x32_bf16 v[84:99], v[232:235], v[196:203], v240
    ds_read_b128 v[232:235], v243 offset:17920
    v_exp_f32 v180, v180
    v_exp_f32 v181, v181
    v_smfmac_f32_32x32x32_bf16 v[68:83], v[228:231], v[204:211], v240
    ds_read_b128 v[228:231], v242 offset:16896
    v_exp_f32 v182, v182
    v_exp_f32 v183, v183
    v_smfmac_f32_32x32x32_bf16 v[84:99], v[236:239], v[204:211], v240
    s_waitcnt lgkmcnt(3)
    ds_read_b128 v[236:239], v244 offset:17920
    v_exp_f32 v184, v184
    v_exp_f32 v185, v185
    v_mfma_f32_32x32x16_bf16 v[196:211], v[212:215], v[12:15], v[148:163]
    v_exp_f32 v186, v186
    v_exp_f32 v187, v187
    v_exp_f32 v188, v188
    v_mfma_f32_32x32x16_bf16 v[196:211], v[216:219], v[16:19], v[196:211]
    ds_read_b128 v[212:215], v241 offset:25600
    ds_read_b128 v[216:219], v241 offset:26624
    v_exp_f32 v189, v189
    v_exp_f32 v190, v190
    v_mfma_f32_32x32x16_bf16 v[196:211], v[220:223], v[20:23], v[196:211]
    s_waitcnt lgkmcnt(2)
    v_exp_f32 v191, v191
    v_exp_f32 v192, v192
    v_exp_f32 v193, v193
    v_smfmac_f32_32x32x32_bf16 v[68:83], v[224:227], v[180:187], v240
    ds_read_b128 v[220:223], v241 offset:27648
    ds_read_b128 v[224:227], v242 offset:22272
    v_exp_f32 v194, v194
    v_exp_f32 v195, v195
    v_smfmac_f32_32x32x32_bf16 v[84:99], v[232:235], v[180:187], v240
    ds_read_b128 v[232:235], v243 offset:24320
    v_exp_f32 v196, v196
    v_exp_f32 v197, v197
    v_smfmac_f32_32x32x32_bf16 v[68:83], v[228:231], v[188:195], v240
    ds_read_b128 v[228:231], v242 offset:23296
    v_exp_f32 v198, v198
    v_exp_f32 v199, v199
    v_smfmac_f32_32x32x32_bf16 v[84:99], v[236:239], v[188:195], v240
    s_waitcnt lgkmcnt(3)
    ds_read_b128 v[236:239], v244 offset:24320
    v_exp_f32 v200, v200
    v_exp_f32 v201, v201
    v_mfma_f32_32x32x16_bf16 v[180:195], v[212:215], v[12:15], v[148:163]
    v_exp_f32 v202, v202
    v_exp_f32 v203, v203
    v_exp_f32 v204, v204
    v_mfma_f32_32x32x16_bf16 v[180:195], v[216:219], v[16:19], v[180:195]
    ds_read_b128 v[212:215], v241 offset:32000
    ds_read_b128 v[216:219], v241 offset:33024
    v_exp_f32 v205, v205
    v_exp_f32 v206, v206
    v_mfma_f32_32x32x16_bf16 v[180:195], v[220:223], v[20:23], v[180:195]
    s_waitcnt lgkmcnt(2)
    v_exp_f32 v207, v207
    v_exp_f32 v208, v208
    v_exp_f32 v209, v209
    v_smfmac_f32_32x32x32_bf16 v[68:83], v[224:227], v[196:203], v240
    ds_read_b128 v[220:223], v241 offset:34048
    ds_read_b128 v[224:227], v242 offset:28672
    v_exp_f32 v210, v210
    v_exp_f32 v211, v211
    v_smfmac_f32_32x32x32_bf16 v[84:99], v[232:235], v[196:203], v240
    ds_read_b128 v[232:235], v243 offset:30720
    v_exp_f32 v180, v180
    v_exp_f32 v181, v181
    v_smfmac_f32_32x32x32_bf16 v[68:83], v[228:231], v[204:211], v240
    ds_read_b128 v[228:231], v242 offset:29696
    v_exp_f32 v182, v182
    v_exp_f32 v183, v183
    v_smfmac_f32_32x32x32_bf16 v[84:99], v[236:239], v[204:211], v240
    s_waitcnt lgkmcnt(3)
    ds_read_b128 v[236:239], v244 offset:30720
    v_exp_f32 v184, v184
    v_exp_f32 v185, v185
    v_mfma_f32_32x32x16_bf16 v[196:211], v[212:215], v[12:15], v[148:163]
    v_exp_f32 v186, v186
    v_exp_f32 v187, v187
    v_exp_f32 v188, v188
    v_mfma_f32_32x32x16_bf16 v[196:211], v[216:219], v[16:19], v[196:211]
    ds_read_b128 v[212:215], v241 offset:38400
    ds_read_b128 v[216:219], v241 offset:39424
    v_exp_f32 v189, v189
    v_exp_f32 v190, v190
    v_mfma_f32_32x32x16_bf16 v[196:211], v[220:223], v[20:23], v[196:211]
    s_waitcnt lgkmcnt(2)
    v_exp_f32 v191, v191
    v_exp_f32 v192, v192
    v_exp_f32 v193, v193
    v_smfmac_f32_32x32x32_bf16 v[68:83], v[224:227], v[180:187], v240
    ds_read_b128 v[220:223], v241 offset:40448
    ds_read_b128 v[224:227], v242 offset:35072
    v_exp_f32 v194, v194
    v_exp_f32 v195, v195
    v_smfmac_f32_32x32x32_bf16 v[84:99], v[232:235], v[180:187], v240
    ds_read_b128 v[232:235], v243 offset:37120
    v_exp_f32 v196, v196
    v_exp_f32 v197, v197
    v_smfmac_f32_32x32x32_bf16 v[68:83], v[228:231], v[188:195], v240
    ds_read_b128 v[228:231], v242 offset:36096
    v_exp_f32 v198, v198
    v_exp_f32 v199, v199
    v_smfmac_f32_32x32x32_bf16 v[84:99], v[236:239], v[188:195], v240
    s_waitcnt lgkmcnt(3)
    ds_read_b128 v[236:239], v244 offset:37120
    v_exp_f32 v200, v200
    v_exp_f32 v201, v201
    v_mfma_f32_32x32x16_bf16 v[180:195], v[212:215], v[12:15], v[148:163]
    v_exp_f32 v202, v202
    v_exp_f32 v203, v203
    v_exp_f32 v204, v204
    v_mfma_f32_32x32x16_bf16 v[180:195], v[216:219], v[16:19], v[180:195]
    ds_read_b128 v[212:215], v241 offset:44800
    ds_read_b128 v[216:219], v241 offset:45824
    v_exp_f32 v205, v205
    v_exp_f32 v206, v206
    v_mfma_f32_32x32x16_bf16 v[180:195], v[220:223], v[20:23], v[180:195]
    s_waitcnt lgkmcnt(2)
    v_exp_f32 v207, v207
    v_exp_f32 v208, v208
    v_exp_f32 v209, v209
    v_smfmac_f32_32x32x32_bf16 v[68:83], v[224:227], v[196:203], v240
    ds_read_b128 v[220:223], v241 offset:46848
    ds_read_b128 v[224:227], v242 offset:41472
    v_exp_f32 v210, v210
    v_exp_f32 v211, v211
    v_smfmac_f32_32x32x32_bf16 v[84:99], v[232:235], v[196:203], v240
    ds_read_b128 v[232:235], v243 offset:43520
    v_exp_f32 v180, v180
    v_exp_f32 v181, v181
    v_smfmac_f32_32x32x32_bf16 v[68:83], v[228:231], v[204:211], v240
    ds_read_b128 v[228:231], v242 offset:42496
    v_exp_f32 v182, v182
    v_exp_f32 v183, v183
    v_smfmac_f32_32x32x32_bf16 v[84:99], v[236:239], v[204:211], v240
    s_waitcnt lgkmcnt(3)
    ds_read_b128 v[236:239], v244 offset:43520
    v_exp_f32 v184, v184
    v_exp_f32 v185, v185
    v_mfma_f32_32x32x16_bf16 v[196:211], v[212:215], v[12:15], v[148:163]
    v_exp_f32 v186, v186
    v_exp_f32 v187, v187
    v_exp_f32 v188, v188
    v_mfma_f32_32x32x16_bf16 v[196:211], v[216:219], v[16:19], v[196:211]
    ds_read_b128 v[212:215], v241 offset:0
    ds_read_b128 v[216:219], v241 offset:1024
    v_exp_f32 v189, v189
    v_exp_f32 v190, v190
    v_mfma_f32_32x32x16_bf16 v[196:211], v[220:223], v[20:23], v[196:211]
    s_waitcnt lgkmcnt(2)
    v_exp_f32 v191, v191
    v_exp_f32 v192, v192
    v_exp_f32 v193, v193
    v_smfmac_f32_32x32x32_bf16 v[68:83], v[224:227], v[180:187], v240
    ds_read_b128 v[220:223], v241 offset:2048
    ds_read_b128 v[224:227], v242 offset:47872
    v_exp_f32 v194, v194
    v_exp_f32 v195, v195
    v_smfmac_f32_32x32x32_bf16 v[84:99], v[232:235], v[180:187], v240
    ds_read_b128 v[232:235], v243 offset:49920
    v_exp_f32 v196, v196
    v_exp_f32 v197, v197
    v_smfmac_f32_32x32x32_bf16 v[68:83], v[228:231], v[188:195], v240
    ds_read_b128 v[228:231], v242 offset:48896
    v_exp_f32 v198, v198
    v_exp_f32 v199, v199
    v_smfmac_f32_32x32x32_bf16 v[84:99], v[236:239], v[188:195], v240
    s_waitcnt lgkmcnt(3)
    ds_read_b128 v[236:239], v244 offset:49920
    v_exp_f32 v200, v200
    v_exp_f32 v201, v201
    v_mfma_f32_32x32x16_bf16 v[180:195], v[212:215], v[24:27], v[164:179]
    v_exp_f32 v202, v202
    v_exp_f32 v203, v203
    v_exp_f32 v204, v204
    v_mfma_f32_32x32x16_bf16 v[180:195], v[216:219], v[28:31], v[180:195]
    ds_read_b128 v[212:215], v241 offset:6400
    ds_read_b128 v[216:219], v241 offset:7424
    v_exp_f32 v205, v205
    v_exp_f32 v206, v206
    v_mfma_f32_32x32x16_bf16 v[180:195], v[220:223], v[32:35], v[180:195]
    s_waitcnt lgkmcnt(2)
    v_exp_f32 v207, v207
    v_exp_f32 v208, v208
    v_exp_f32 v209, v209
    v_smfmac_f32_32x32x32_bf16 v[68:83], v[224:227], v[196:203], v240
    ds_read_b128 v[220:223], v241 offset:8448
    ds_read_b128 v[224:227], v242 offset:3072
    v_exp_f32 v210, v210
    v_exp_f32 v211, v211
    v_smfmac_f32_32x32x32_bf16 v[84:99], v[232:235], v[196:203], v240
    ds_read_b128 v[232:235], v243 offset:5120
    v_exp_f32 v180, v180
    v_exp_f32 v181, v181
    v_smfmac_f32_32x32x32_bf16 v[68:83], v[228:231], v[204:211], v240
    ds_read_b128 v[228:231], v242 offset:4096
    v_exp_f32 v182, v182
    v_exp_f32 v183, v183
    v_smfmac_f32_32x32x32_bf16 v[84:99], v[236:239], v[204:211], v240
    s_waitcnt lgkmcnt(3)
    ds_read_b128 v[236:239], v244 offset:5120
    v_exp_f32 v184, v184
    v_exp_f32 v185, v185
    v_mfma_f32_32x32x16_bf16 v[196:211], v[212:215], v[24:27], v[164:179]
    v_exp_f32 v186, v186
    v_exp_f32 v187, v187
    v_exp_f32 v188, v188
    v_mfma_f32_32x32x16_bf16 v[196:211], v[216:219], v[28:31], v[196:211]
    ds_read_b128 v[212:215], v241 offset:12800
    ds_read_b128 v[216:219], v241 offset:13824
    v_exp_f32 v189, v189
    v_exp_f32 v190, v190
    v_mfma_f32_32x32x16_bf16 v[196:211], v[220:223], v[32:35], v[196:211]
    s_waitcnt lgkmcnt(2)
    v_exp_f32 v191, v191
    v_exp_f32 v192, v192
    v_exp_f32 v193, v193
    v_smfmac_f32_32x32x32_bf16 v[100:115], v[224:227], v[180:187], v240
    ds_read_b128 v[220:223], v241 offset:14848
    ds_read_b128 v[224:227], v242 offset:9472
    v_exp_f32 v194, v194
    v_exp_f32 v195, v195
    v_smfmac_f32_32x32x32_bf16 v[116:131], v[232:235], v[180:187], v240
    s_cmp_eq_u32 s98, 1
    s_cbranch_scc0 L_fs1
    v_mov_b32 v250, v92
    v_mov_b32 v248, 0
    v_mov_b32 v249, 0
    v_permlane32_swap_b32 v92, v250
    v_pk_fma_f32 v[248:249], v[68:69], 0, v[248:249] op_sel_hi:[1,0,1]
    v_pk_fma_f32 v[248:249], v[70:71], 0, v[248:249] op_sel_hi:[1,0,1]
    v_pk_fma_f32 v[248:249], v[72:73], 0, v[248:249] op_sel_hi:[1,0,1]
    v_pk_fma_f32 v[248:249], v[74:75], 0, v[248:249] op_sel_hi:[1,0,1]
    v_pk_fma_f32 v[248:249], v[76:77], 0, v[248:249] op_sel_hi:[1,0,1]
    v_pk_fma_f32 v[248:249], v[78:79], 0, v[248:249] op_sel_hi:[1,0,1]
    v_pk_fma_f32 v[248:249], v[80:81], 0, v[248:249] op_sel_hi:[1,0,1]
    v_pk_fma_f32 v[248:249], v[82:83], 0, v[248:249] op_sel_hi:[1,0,1]
    v_pk_fma_f32 v[248:249], v[84:85], 0, v[248:249] op_sel_hi:[1,0,1]
    v_pk_fma_f32 v[248:249], v[86:87], 0, v[248:249] op_sel_hi:[1,0,1]
    v_pk_fma_f32 v[248:249], v[88:89], 0, v[248:249] op_sel_hi:[1,0,1]
    v_pk_fma_f32 v[248:249], v[90:91], 0, v[248:249] op_sel_hi:[1,0,1]
    v_cmp_gt_f32 vcc, 0x71800000, v92
    v_add_f32 v248, v248, v249
    s_mov_b64 s[6:7], vcc
    v_cmp_o_f32 vcc, v248, v248
    s_nop 0
    s_and_b64 vcc, vcc, s[6:7]
    s_cmp_eq_u64 vcc, -1
    s_cbranch_scc0 L_f1fail
    s_mov_b32 s90, s9
    s_mov_b32 s91, s85
    v_mov_b32 v151, s92
    v_mov_b32 v155, s92
    v_mov_b32 v159, s92
    v_mov_b32 v163, s92
    v_mov_b32 v250, v92
    s_nop 1
    v_permlane32_swap_b32 v92, v250
    s_nop 1
    v_rcp_f32 v248, v92
    s_nop 0
    v_pk_mul_f32 v[68:69], v[68:69], v[248:249] op_sel_hi:[1,0]
    v_pk_mul_f32 v[70:71], v[70:71], v[248:249] op_sel_hi:[1,0]
    v_pk_mul_f32 v[72:73], v[72:73], v[248:249] op_sel_hi:[1,0]
    v_pk_mul_f32 v[74:75], v[74:75], v[248:249] op_sel_hi:[1,0]
    v_pk_mul_f32 v[76:77], v[76:77], v[248:249] op_sel_hi:[1,0]
    v_pk_mul_f32 v[78:79], v[78:79], v[248:249] op_sel_hi:[1,0]
    v_pk_mul_f32 v[80:81], v[80:81], v[248:249] op_sel_hi:[1,0]
    v_pk_mul_f32 v[82:83], v[82:83], v[248:249] op_sel_hi:[1,0]
    v_pk_mul_f32 v[84:85], v[84:85], v[248:249] op_sel_hi:[1,0]
    v_pk_mul_f32 v[86:87], v[86:87], v[248:249] op_sel_hi:[1,0]
    v_pk_mul_f32 v[88:89], v[88:89], v[248:249] op_sel_hi:[1,0]
    v_pk_mul_f32 v[90:91], v[90:91], v[248:249] op_sel_hi:[1,0]
    v_cvt_pk_bf16_f32 v148, v68, v69
    v_cvt_pk_bf16_f32 v149, v70, v71
    v_cvt_pk_bf16_f32 v150, v72, v73
    v_cvt_pk_bf16_f32 v152, v74, v75
    v_cvt_pk_bf16_f32 v153, v76, v77
    v_cvt_pk_bf16_f32 v154, v78, v79
    v_cvt_pk_bf16_f32 v156, v80, v81
    v_cvt_pk_bf16_f32 v157, v82, v83
    v_cvt_pk_bf16_f32 v158, v84, v85
    v_cvt_pk_bf16_f32 v160, v86, v87
    v_cvt_pk_bf16_f32 v161, v88, v89
    v_cvt_pk_bf16_f32 v162, v90, v91
    buffer_store_dwordx4 v[148:151], v254, s[20:23], s90 offen offset:0 sc1
    buffer_store_dwordx4 v[152:155], v254, s[20:23], s90 offen offset:1024 sc1
    buffer_store_dwordx4 v[156:159], v254, s[20:23], s90 offen offset:2048 sc1
    buffer_store_dwordx4 v[160:163], v254, s[20:23], s90 offen offset:3072 sc1
L_fs1:
    ds_read_b128 v[232:235], v243 offset:11520
    v_exp_f32 v196, v196
    v_exp_f32 v197, v197
    v_smfmac_f32_32x32x32_bf16 v[100:115], v[228:231], v[188:195], v240
    ds_read_b128 v[228:231], v242 offset:10496
    v_exp_f32 v198, v198
    v_exp_f32 v199, v199
    v_smfmac_f32_32x32x32_bf16 v[116:131], v[236:239], v[188:195], v240
    s_waitcnt lgkmcnt(3)
    ds_read_b128 v[236:239], v244 offset:11520
    v_exp_f32 v200, v200
    v_exp_f32 v201, v201
    v_mfma_f32_32x32x16_bf16 v[180:195], v[212:215], v[24:27], v[164:179]
    v_exp_f32 v202, v202
    v_exp_f32 v203, v203
    v_exp_f32 v204, v204
    v_mfma_f32_32x32x16_bf16 v[180:195], v[216:219], v[28:31], v[180:195]
    ds_read_b128 v[212:215], v241 offset:19200
    ds_read_b128 v[216:219], v241 offset:20224
    v_exp_f32 v205, v205
    v_exp_f32 v206, v206
    v_mfma_f32_32x32x16_bf16 v[180:195], v[220:223], v[32:35], v[180:195]
    s_waitcnt lgkmcnt(2)
    v_exp_f32 v207, v207
    v_exp_f32 v208, v208
    v_exp_f32 v209, v209
    v_smfmac_f32_32x32x32_bf16 v[100:115], v[224:227], v[196:203], v240
    ds_read_b128 v[220:223], v241 offset:21248
    ds_read_b128 v[224:227], v242 offset:15872
    v_exp_f32 v210, v210
    v_exp_f32 v211, v211
    v_smfmac_f32_32x32x32_bf16 v[116:131], v[232:235], v[196:203], v240
    ds_read_b128 v[232:235], v243 offset:17920
    v_exp_f32 v180, v180
    v_exp_f32 v181, v181
    v_smfmac_f32_32x32x32_bf16 v[100:115], v[228:231], v[204:211], v240
    ds_read_b128 v[228:231], v242 offset:16896
    v_exp_f32 v182, v182
    v_exp_f32 v183, v183
    v_smfmac_f32_32x32x32_bf16 v[116:131], v[236:239], v[204:211], v240
    s_waitcnt lgkmcnt(3)
    ds_read_b128 v[236:239], v244 offset:17920
    v_exp_f32 v184, v184
    v_exp_f32 v185, v185
    v_mfma_f32_32x32x16_bf16 v[196:211], v[212:215], v[24:27], v[164:179]
    v_exp_f32 v186, v186
    v_exp_f32 v187, v187
    v_exp_f32 v188, v188
    v_mfma_f32_32x32x16_bf16 v[196:211], v[216:219], v[28:31], v[196:211]
    ds_read_b128 v[212:215], v241 offset:25600
    ds_read_b128 v[216:219], v241 offset:26624
    v_exp_f32 v189, v189
    v_exp_f32 v190, v190
    v_mfma_f32_32x32x16_bf16 v[196:211], v[220:223], v[32:35], v[196:211]
    s_waitcnt lgkmcnt(2)
    v_exp_f32 v191, v191
    v_exp_f32 v192, v192
    v_exp_f32 v193, v193
    v_smfmac_f32_32x32x32_bf16 v[100:115], v[224:227], v[180:187], v240
    ds_read_b128 v[220:223], v241 offset:27648
    ds_read_b128 v[224:227], v242 offset:22272
    v_exp_f32 v194, v194
    v_exp_f32 v195, v195
    v_smfmac_f32_32x32x32_bf16 v[116:131], v[232:235], v[180:187], v240
    ds_read_b128 v[232:235], v243 offset:24320
    v_exp_f32 v196, v196
    v_exp_f32 v197, v197
    v_smfmac_f32_32x32x32_bf16 v[100:115], v[228:231], v[188:195], v240
    ds_read_b128 v[228:231], v242 offset:23296
    v_exp_f32 v198, v198
    v_exp_f32 v199, v199
    v_smfmac_f32_32x32x32_bf16 v[116:131], v[236:239], v[188:195], v240
    s_waitcnt lgkmcnt(3)
    ds_read_b128 v[236:239], v244 offset:24320
    v_exp_f32 v200, v200
    v_exp_f32 v201, v201
    v_mfma_f32_32x32x16_bf16 v[180:195], v[212:215], v[24:27], v[164:179]
    v_exp_f32 v202, v202
    v_exp_f32 v203, v203
    v_exp_f32 v204, v204
    v_mfma_f32_32x32x16_bf16 v[180:195], v[216:219], v[28:31], v[180:195]
    ds_read_b128 v[212:215], v241 offset:32000
    ds_read_b128 v[216:219], v241 offset:33024
    v_exp_f32 v205, v205
    v_exp_f32 v206, v206
    v_mfma_f32_32x32x16_bf16 v[180:195], v[220:223], v[32:35], v[180:195]
    s_waitcnt lgkmcnt(2)
    v_exp_f32 v207, v207
    v_exp_f32 v208, v208
    v_exp_f32 v209, v209
    v_smfmac_f32_32x32x32_bf16 v[100:115], v[224:227], v[196:203], v240
    ds_read_b128 v[220:223], v241 offset:34048
    ds_read_b128 v[224:227], v242 offset:28672
    v_exp_f32 v210, v210
    v_exp_f32 v211, v211
    v_smfmac_f32_32x32x32_bf16 v[116:131], v[232:235], v[196:203], v240
    ds_read_b128 v[232:235], v243 offset:30720
    v_exp_f32 v180, v180
    v_exp_f32 v181, v181
    v_smfmac_f32_32x32x32_bf16 v[100:115], v[228:231], v[204:211], v240
    ds_read_b128 v[228:231], v242 offset:29696
    v_exp_f32 v182, v182
    v_exp_f32 v183, v183
    v_smfmac_f32_32x32x32_bf16 v[116:131], v[236:239], v[204:211], v240
    s_waitcnt lgkmcnt(3)
    ds_read_b128 v[236:239], v244 offset:30720
    v_exp_f32 v184, v184
    v_exp_f32 v185, v185
    v_mfma_f32_32x32x16_bf16 v[196:211], v[212:215], v[24:27], v[164:179]
    v_exp_f32 v186, v186
    v_exp_f32 v187, v187
    v_exp_f32 v188, v188
    v_mfma_f32_32x32x16_bf16 v[196:211], v[216:219], v[28:31], v[196:211]
    ds_read_b128 v[212:215], v241 offset:38400
    ds_read_b128 v[216:219], v241 offset:39424
    v_exp_f32 v189, v189
    v_exp_f32 v190, v190
    v_mfma_f32_32x32x16_bf16 v[196:211], v[220:223], v[32:35], v[196:211]
    s_waitcnt lgkmcnt(2)
    v_exp_f32 v191, v191
    v_exp_f32 v192, v192
    v_exp_f32 v193, v193
    v_smfmac_f32_32x32x32_bf16 v[100:115], v[224:227], v[180:187], v240
    ds_read_b128 v[220:223], v241 offset:40448
    ds_read_b128 v[224:227], v242 offset:35072
    v_exp_f32 v194, v194
    v_exp_f32 v195, v195
    v_smfmac_f32_32x32x32_bf16 v[116:131], v[232:235], v[180:187], v240
    ds_read_b128 v[232:235], v243 offset:37120
    v_exp_f32 v196, v196
    v_exp_f32 v197, v197
    v_smfmac_f32_32x32x32_bf16 v[100:115], v[228:231], v[188:195], v240
    ds_read_b128 v[228:231], v242 offset:36096
    v_exp_f32 v198, v198
    v_exp_f32 v199, v199
    v_smfmac_f32_32x32x32_bf16 v[116:131], v[236:239], v[188:195], v240
    s_waitcnt lgkmcnt(3)
    ds_read_b128 v[236:239], v244 offset:37120
    v_exp_f32 v200, v200
    v_exp_f32 v201, v201
    v_mfma_f32_32x32x16_bf16 v[180:195], v[212:215], v[24:27], v[164:179]
    v_exp_f32 v202, v202
    v_exp_f32 v203, v203
    v_exp_f32 v204, v204
    v_mfma_f32_32x32x16_bf16 v[180:195], v[216:219], v[28:31], v[180:195]
    ds_read_b128 v[212:215], v241 offset:44800
    ds_read_b128 v[216:219], v241 offset:45824
    v_exp_f32 v205, v205
    v_exp_f32 v206, v206
    v_mfma_f32_32x32x16_bf16 v[180:195], v[220:223], v[32:35], v[180:195]
    s_waitcnt lgkmcnt(2)
    v_exp_f32 v207, v207
    v_exp_f32 v208, v208
    v_exp_f32 v209, v209
    v_smfmac_f32_32x32x32_bf16 v[100:115], v[224:227], v[196:203], v240
    ds_read_b128 v[220:223], v241 offset:46848
    ds_read_b128 v[224:227], v242 offset:41472
    v_exp_f32 v210, v210
    v_exp_f32 v211, v211
    v_smfmac_f32_32x32x32_bf16 v[116:131], v[232:235], v[196:203], v240
    ds_read_b128 v[232:235], v243 offset:43520
    v_exp_f32 v180, v180
    v_exp_f32 v181, v181
    v_smfmac_f32_32x32x32_bf16 v[100:115], v[228:231], v[204:211], v240
    ds_read_b128 v[228:231], v242 offset:42496
    v_exp_f32 v182, v182
    v_exp_f32 v183, v183
    v_smfmac_f32_32x32x32_bf16 v[116:131], v[236:239], v[204:211], v240
    s_waitcnt lgkmcnt(3)
    ds_read_b128 v[236:239], v244 offset:43520
    v_exp_f32 v184, v184
    v_exp_f32 v185, v185
    v_mfma_f32_32x32x16_bf16 v[196:211], v[212:215], v[24:27], v[164:179]
    v_exp_f32 v186, v186
    v_exp_f32 v187, v187
    v_exp_f32 v188, v188
    v_mfma_f32_32x32x16_bf16 v[196:211], v[216:219], v[28:31], v[196:211]
    v_add_u32 v241, s33, v241
    ds_read_b128 v[212:215], v241 offset:0
    ds_read_b128 v[216:219], v241 offset:1024
    v_exp_f32 v189, v189
    v_exp_f32 v190, v190
    v_mfma_f32_32x32x16_bf16 v[196:211], v[220:223], v[32:35], v[196:211]
    s_waitcnt lgkmcnt(2)
    v_exp_f32 v191, v191
    v_exp_f32 v192, v192
    v_exp_f32 v193, v193
    v_smfmac_f32_32x32x32_bf16 v[100:115], v[224:227], v[180:187], v240
    ds_read_b128 v[220:223], v241 offset:2048
    ds_read_b128 v[224:227], v242 offset:47872
    v_exp_f32 v194, v194
    v_exp_f32 v195, v195
    v_smfmac_f32_32x32x32_bf16 v[116:131], v[232:235], v[180:187], v240
    s_mov_b32 s90, s10
    s_mov_b32 s91, s86
    buffer_load_dwordx4 v[132:135], v254, s[20:23], s90 offen offset:0 sc1
    buffer_load_dwordx4 v[136:139], v254, s[20:23], s90 offen offset:1024 sc1
    buffer_load_dwordx4 v[140:143], v254, s[20:23], s90 offen offset:2048 sc1
    buffer_load_dwordx4 v[144:147], v254, s[20:23], s90 offen offset:3072 sc1
    s_cmp_eq_u32 s98, 0
    s_cbranch_scc0 L_fsp
    s_mov_b32 s90, s9
    s_mov_b32 s91, s85
    buffer_load_dwordx4 v[148:151], v254, s[20:23], s90 offen offset:0 sc1
    buffer_load_dwordx4 v[152:155], v254, s[20:23], s90 offen offset:1024 sc1
    buffer_load_dwordx4 v[156:159], v254, s[20:23], s90 offen offset:2048 sc1
    buffer_load_dwordx4 v[160:163], v254, s[20:23], s90 offen offset:3072 sc1
L_fsp:
    ds_read_b128 v[232:235], v243 offset:49920
    v_exp_f32 v196, v196
    v_exp_f32 v197, v197
    v_smfmac_f32_32x32x32_bf16 v[100:115], v[228:231], v[188:195], v240
    ds_read_b128 v[228:231], v242 offset:48896
    v_exp_f32 v198, v198
    v_exp_f32 v199, v199
    v_smfmac_f32_32x32x32_bf16 v[116:131], v[236:239], v[188:195], v240
    s_waitcnt lgkmcnt(3)
    ds_read_b128 v[236:239], v244 offset:49920
    v_exp_f32 v200, v200
    v_exp_f32 v201, v201
    v_mfma_f32_32x32x16_bf16 v[180:195], v[212:215], v[0:3], v[132:147]
    v_exp_f32 v202, v202
    v_exp_f32 v203, v203
    v_exp_f32 v204, v204
    v_mfma_f32_32x32x16_bf16 v[180:195], v[216:219], v[4:7], v[180:195]
    ds_read_b128 v[212:215], v241 offset:6400
    ds_read_b128 v[216:219], v241 offset:7424
    v_add_u32 v242, s33, v242
    v_add_u32 v243, s33, v243
    v_add_u32 v244, s33, v244
    v_exp_f32 v205, v205
    v_exp_f32 v206, v206
    v_mfma_f32_32x32x16_bf16 v[180:195], v[220:223], v[8:11], v[180:195]
    s_waitcnt lgkmcnt(2)
    v_exp_f32 v207, v207
    v_exp_f32 v208, v208
    v_exp_f32 v209, v209
    v_smfmac_f32_32x32x32_bf16 v[100:115], v[224:227], v[196:203], v240
    ds_read_b128 v[220:223], v241 offset:8448
    ds_read_b128 v[224:227], v242 offset:3072
    v_exp_f32 v210, v210
    v_exp_f32 v211, v211
    v_smfmac_f32_32x32x32_bf16 v[116:131], v[232:235], v[196:203], v240
    ds_read_b128 v[232:235], v243 offset:5120
    v_exp_f32 v180, v180
    v_exp_f32 v181, v181
    v_smfmac_f32_32x32x32_bf16 v[100:115], v[228:231], v[204:211], v240
    ds_read_b128 v[228:231], v242 offset:4096
    v_exp_f32 v182, v182
    v_exp_f32 v183, v183
    v_smfmac_f32_32x32x32_bf16 v[116:131], v[236:239], v[204:211], v240
    s_waitcnt lgkmcnt(3)
    s_barrier
    ds_read_b128 v[236:239], v244 offset:5120
    v_exp_f32 v184, v184
    v_exp_f32 v185, v185
    s_branch L_epi
L_midA:
    s_barrier
    s_branch L_backA
L_f0fail:
    s_or_b32 s96, s96, 1
    s_branch L_f0done
L_f1fail:
    s_or_b32 s96, s96, 2
    s_branch L_fs1
L_arrA:
    s_waitcnt vmcnt(0)
    v_mov_b32 v248, 153600
    v_mov_b32 v249, 1
    s_mov_b64 exec, 1
    ds_add_u32 v248, v249
    s_mov_b64 exec, -1
    s_branch L_arrA_ret
L_B:
    s_setprio 2
    v_mfma_f32_32x32x16_bf16 v[180:195], v[212:215], v[0:3], 0
    v_mfma_f32_32x32x16_bf16 v[180:195], v[216:219], v[4:7], v[180:195]
    v_mfma_f32_32x32x16_bf16 v[180:195], v[220:223], v[8:11], v[180:195]
    s_nop 15
    v_max3_f32 v249, v180, v181, v182
    v_max3_f32 v249, v249, v183, v184
    v_max3_f32 v249, v249, v185, v186
    v_max3_f32 v249, v249, v187, v188
    v_max3_f32 v249, v249, v189, v190
    v_max3_f32 v249, v249, v191, v192
    v_max3_f32 v249, v249, v193, v194
    v_max_f32 v249, v249, v195
    v_mov_b32 v250, v249
    s_nop 1
    v_permlane32_swap_b32 v249, v250
    s_nop 1
    v_max_f32 v249, v249, v250
    v_sub_f32 v132, 0, v249
    v_sub_f32 v133, 0, v249
    v_sub_f32 v134, 0, v249
    v_sub_f32 v135, 0, v249
    v_sub_f32 v136, 0, v249
    v_sub_f32 v137, 0, v249
    v_sub_f32 v138, 0, v249
    v_sub_f32 v139, 0, v249
    v_sub_f32 v140, 0, v249
    v_sub_f32 v141, 0, v249
    v_sub_f32 v142, 0, v249
    v_sub_f32 v143, 0, v249
    v_sub_f32 v144, 0, v249
    v_sub_f32 v145, 0, v249
    v_sub_f32 v146, 0, v249
    v_sub_f32 v147, 0, v249
    s_waitcnt vmcnt(0)
    v_readfirstlane_b32 s92, v237
    s_cmp_lg_u32 s92, 0
    s_cbranch_scc1 L_Bn
    s_mov_b32 s37, 0
L_gnB:
    v_mov_b32 v248, 4
    global_load_dword v249, v248, s[68:69] sc1
    s_waitcnt vmcnt(0)
    v_readfirstlane_b32 s92, v249
    s_cmp_lg_u32 s92, 0
    s_cbranch_scc1 L_gndB
    s_add_u32 s37, s37, 1
    s_cmp_lt_u32 s37, 0x40000
    s_cbranch_scc1 L_gnB
L_gndB:
L_Bn:
    s_waitcnt vmcnt(0)
    v_mov_b32 v248, 153600
    v_mov_b32 v249, 1
    s_mov_b64 exec, 1
    ds_add_u32 v248, v249
    s_mov_b64 exec, -1
    s_cmp_eq_u32 s49, 0
    s_cbranch_scc0 L_nopubB
    s_mov_b32 s37, 0
L_cwB:
    ds_read_b32 v250, v248
    s_waitcnt lgkmcnt(0)
    v_readfirstlane_b32 s34, v250
    s_cmp_eq_u32 s34, 8
    s_cbranch_scc1 L_cgB
    s_sleep 1
    s_add_u32 s37, s37, 1
    s_cmp_lt_u32 s37, 0x100000
    s_cbranch_scc1 L_cwB
L_cgB:
    s_mov_b64 exec, 1
    v_mov_b32 v251, v238
    s_mul_i32 s35, s42, s42
    s_lshl_b32 s35, s35, 18
    s_lshl_b32 s36, s42, 10
    s_add_u32 s35, s35, s36
    s_add_u32 s35, s35, 4
    v_readfirstlane_b32 s34, v251
    s_lshl_b32 s36, s24, 2
    s_add_u32 s36, s36, s25
    s_lshl_b32 s36, s36, 7
    s_add_u32 s36, s36, 25690112
    v_mov_b32 v248, 0
    v_mov_b32 v249, s92
    s_cmp_eq_u32 s34, s35
    s_cbranch_scc1 L_fastB
    buffer_wbl2 sc1
    s_waitcnt vmcnt(0)
    buffer_store_dword v249, v248, s[20:23], s36 offen sc1
    s_branch L_nopubB
L_fastB:
    buffer_store_dword v249, v248, s[20:23], s36 offen
L_nopubB:
    s_mov_b64 exec, -1
    s_waitcnt lgkmcnt(0)
    ds_read_b128 v[212:215], v241 offset:0
    ds_read_b128 v[216:219], v241 offset:1024
    ds_read_b128 v[220:223], v241 offset:2048
    ds_read_b128 v[224:227], v242 offset:3072
    ds_read_b128 v[228:231], v242 offset:4096
    ds_read_b128 v[232:235], v243 offset:5120
    ds_read_b128 v[236:239], v244 offset:5120
    s_waitcnt lgkmcnt(4)
    v_mfma_f32_32x32x16_bf16 v[180:195], v[212:215], v[0:3], v[132:147]
    v_mfma_f32_32x32x16_bf16 v[180:195], v[216:219], v[4:7], v[180:195]
    v_mfma_f32_32x32x16_bf16 v[180:195], v[220:223], v[8:11], v[180:195]
    ds_read_b128 v[212:215], v241 offset:12800
    ds_read_b128 v[216:219], v241 offset:13824
    ds_read_b128 v[220:223], v241 offset:14848
    s_nop 15
    v_exp_f32 v180, v180
    v_exp_f32 v181, v181
    v_exp_f32 v182, v182
    v_exp_f32 v183, v183
    v_exp_f32 v184, v184
    v_exp_f32 v185, v185
    s_waitcnt lgkmcnt(0)
    s_mov_b32 s31, 0
    s_mov_b32 s32, 0
    s_mov_b32 s93, 0
.p2align 6
L_loopB:
    s_cmp_eq_u32 s32, 2
    s_cselect_b32 s33, s39, s38
    s_cmp_eq_u32 s31, 0
    s_cbranch_scc1 L_B_nd
    s_cmp_eq_u32 s93, 0
    s_cbranch_scc1 L_firstB
L_firstB_ret:
    s_cmp_ge_u32 s31, 5
    s_cbranch_scc1 L_B_nd
    s_add_u32 s74, s31, 2
    s_lshl_b32 s74, s74, 3
    s_lshl_b32 s34, s49, 1
    s_add_u32 s74, s74, s34
    s_add_u32 s34, s74, s28
    s_cmp_ge_u32 s34, 56
    s_cselect_b32 s35, 56, 0
    s_sub_u32 s34, s34, s35
    s_cmp_ge_u32 s74, 24
    s_cselect_b32 s35, 24, 0
    s_sub_u32 s35, s74, s35
    s_cmp_ge_u32 s35, 24
    s_cselect_b32 s36, 24, 0
    s_sub_u32 s35, s35, s36
    s_mul_i32 s36, s34, 6144
    s_add_u32 s36, s36, s40
    s_mul_i32 m0, s35, 6400
    s_nop 0
    buffer_load_dwordx4 v254, s[20:23], s36 offen offset:0 sc1 lds
    buffer_load_dwordx4 v254, s[20:23], s36 offen offset:1024 sc1 lds
    buffer_load_dwordx4 v254, s[20:23], s36 offen offset:2048 sc1 lds
    buffer_load_dwordx4 v254, s[20:23], s36 offen offset:3072 sc1 lds
    s_add_u32 s36, s36, 4096
    s_add_u32 m0, m0, 4096
    s_nop 0
    buffer_load_dwordx4 v254, s[20:23], s36 offen offset:0 sc1 lds
    buffer_load_dwordx4 v254, s[20:23], s36 offen offset:1024 sc1 lds
    s_add_u32 s74, s74, 1
    s_add_u32 s34, s74, s28
    s_cmp_ge_u32 s34, 56
    s_cselect_b32 s35, 56, 0
    s_sub_u32 s34, s34, s35
    s_cmp_ge_u32 s74, 24
    s_cselect_b32 s35, 24, 0
    s_sub_u32 s35, s74, s35
    s_cmp_ge_u32 s35, 24
    s_cselect_b32 s36, 24, 0
    s_sub_u32 s35, s35, s36
    s_mul_i32 s36, s34, 6144
    s_add_u32 s36, s36, s40
    s_mul_i32 m0, s35, 6400
    s_nop 0
    buffer_load_dwordx4 v254, s[20:23], s36 offen offset:0 sc1 lds
    buffer_load_dwordx4 v254, s[20:23], s36 offen offset:1024 sc1 lds
    buffer_load_dwordx4 v254, s[20:23], s36 offen offset:2048 sc1 lds
    buffer_load_dwordx4 v254, s[20:23], s36 offen offset:3072 sc1 lds
    s_add_u32 s36, s36, 4096
    s_add_u32 m0, m0, 4096
    s_nop 0
    buffer_load_dwordx4 v254, s[20:23], s36 offen offset:0 sc1 lds
    buffer_load_dwordx4 v254, s[20:23], s36 offen offset:1024 sc1 lds
L_B_nd:
    s_cmp_eq_u32 s31, 3
    s_cbranch_scc0 L_nowb
    s_cmp_eq_u32 s26, 7
    s_cbranch_scc0 L_nowb
    s_cmp_lt_u32 s2, 8
    s_cbranch_scc0 L_nowb
    buffer_wbl2 sc1
L_nowb:
    s_cmp_eq_u32 s31, 6
    s_cbranch_scc0 L_B_nwo
    s_mov_b32 s74, s49
L_wo:
    s_lshl_b32 s34, s74, 10
    s_add_u32 m0, s34, 102400
    s_nop 0
    buffer_load_dwordx4 v254, s[76:79], s34 offen lds
    s_add_u32 s74, s74, 4
    s_cmp_lt_u32 s74, 18
    s_cbranch_scc1 L_wo
L_B_nwo:
    v_mfma_f32_32x32x16_bf16 v[196:211], v[212:215], v[0:3], v[132:147]
    v_exp_f32 v186, v186
    v_exp_f32 v187, v187
    v_exp_f32 v188, v188
    v_mfma_f32_32x32x16_bf16 v[196:211], v[216:219], v[4:7], v[196:211]
    ds_read_b128 v[212:215], v241 offset:25600
    ds_read_b128 v[216:219], v241 offset:26624
    v_exp_f32 v189, v189
    v_exp_f32 v190, v190
    v_mfma_f32_32x32x16_bf16 v[196:211], v[220:223], v[8:11], v[196:211]
    s_waitcnt lgkmcnt(2)
    v_exp_f32 v191, v191
    v_exp_f32 v192, v192
    v_exp_f32 v193, v193
    v_smfmac_f32_32x32x32_bf16 v[36:51], v[224:227], v[180:187], v240
    ds_read_b128 v[220:223], v241 offset:27648
    ds_read_b128 v[224:227], v242 offset:15872
    v_exp_f32 v194, v194
    v_exp_f32 v195, v195
    v_smfmac_f32_32x32x32_bf16 v[52:67], v[232:235], v[180:187], v240
    ds_read_b128 v[232:235], v243 offset:17920
    v_exp_f32 v196, v196
    v_exp_f32 v197, v197
    v_smfmac_f32_32x32x32_bf16 v[36:51], v[228:231], v[188:195], v240
    ds_read_b128 v[228:231], v242 offset:16896
    v_exp_f32 v198, v198
    v_exp_f32 v199, v199
    v_smfmac_f32_32x32x32_bf16 v[52:67], v[236:239], v[188:195], v240
    s_waitcnt lgkmcnt(3)
    ds_read_b128 v[236:239], v244 offset:17920
    v_exp_f32 v200, v200
    v_exp_f32 v201, v201
    v_mfma_f32_32x32x16_bf16 v[180:195], v[212:215], v[0:3], v[132:147]
    s_cmp_eq_u32 s31, 1
    s_cbranch_scc1 L_midB
L_backB:
    v_exp_f32 v202, v202
    v_exp_f32 v203, v203
    v_exp_f32 v204, v204
    v_mfma_f32_32x32x16_bf16 v[180:195], v[216:219], v[4:7], v[180:195]
    ds_read_b128 v[212:215], v241 offset:38400
    ds_read_b128 v[216:219], v241 offset:39424
    v_exp_f32 v205, v205
    v_exp_f32 v206, v206
    v_mfma_f32_32x32x16_bf16 v[180:195], v[220:223], v[8:11], v[180:195]
    s_waitcnt lgkmcnt(2)
    v_exp_f32 v207, v207
    v_exp_f32 v208, v208
    v_exp_f32 v209, v209
    v_smfmac_f32_32x32x32_bf16 v[36:51], v[224:227], v[196:203], v240
    ds_read_b128 v[220:223], v241 offset:40448
    ds_read_b128 v[224:227], v242 offset:28672
    v_exp_f32 v210, v210
    v_exp_f32 v211, v211
    v_smfmac_f32_32x32x32_bf16 v[52:67], v[232:235], v[196:203], v240
    ds_read_b128 v[232:235], v243 offset:30720
    v_exp_f32 v180, v180
    v_exp_f32 v181, v181
    v_smfmac_f32_32x32x32_bf16 v[36:51], v[228:231], v[204:211], v240
    ds_read_b128 v[228:231], v242 offset:29696
    v_exp_f32 v182, v182
    v_exp_f32 v183, v183
    v_smfmac_f32_32x32x32_bf16 v[52:67], v[236:239], v[204:211], v240
    s_waitcnt lgkmcnt(3)
    ds_read_b128 v[236:239], v244 offset:30720
    v_exp_f32 v184, v184
    v_exp_f32 v185, v185
    v_mfma_f32_32x32x16_bf16 v[196:211], v[212:215], v[0:3], v[132:147]
    v_exp_f32 v186, v186
    v_exp_f32 v187, v187
    v_exp_f32 v188, v188
    v_mfma_f32_32x32x16_bf16 v[196:211], v[216:219], v[4:7], v[196:211]
    v_add_u32 v241, s33, v241
    ds_read_b128 v[212:215], v241 offset:0
    ds_read_b128 v[216:219], v241 offset:1024
    v_exp_f32 v189, v189
    v_exp_f32 v190, v190
    v_mfma_f32_32x32x16_bf16 v[196:211], v[220:223], v[8:11], v[196:211]
    s_waitcnt lgkmcnt(2)
    v_exp_f32 v191, v191
    v_exp_f32 v192, v192
    v_exp_f32 v193, v193
    v_smfmac_f32_32x32x32_bf16 v[36:51], v[224:227], v[180:187], v240
    ds_read_b128 v[220:223], v241 offset:2048
    ds_read_b128 v[224:227], v242 offset:41472
    v_exp_f32 v194, v194
    v_exp_f32 v195, v195
    v_smfmac_f32_32x32x32_bf16 v[52:67], v[232:235], v[180:187], v240
    ds_read_b128 v[232:235], v243 offset:43520
    v_exp_f32 v196, v196
    v_exp_f32 v197, v197
    v_smfmac_f32_32x32x32_bf16 v[36:51], v[228:231], v[188:195], v240
    ds_read_b128 v[228:231], v242 offset:42496
    v_exp_f32 v198, v198
    v_exp_f32 v199, v199
    v_smfmac_f32_32x32x32_bf16 v[52:67], v[236:239], v[188:195], v240
    s_waitcnt lgkmcnt(3)
    ds_read_b128 v[236:239], v244 offset:43520
    v_exp_f32 v200, v200
    v_exp_f32 v201, v201
    v_mfma_f32_32x32x16_bf16 v[180:195], v[212:215], v[0:3], v[132:147]
    v_exp_f32 v202, v202
    v_exp_f32 v203, v203
    v_exp_f32 v204, v204
    v_mfma_f32_32x32x16_bf16 v[180:195], v[216:219], v[4:7], v[180:195]
    ds_read_b128 v[212:215], v241 offset:12800
    ds_read_b128 v[216:219], v241 offset:13824
    v_add_u32 v242, s33, v242
    v_add_u32 v243, s33, v243
    v_add_u32 v244, s33, v244
    v_exp_f32 v205, v205
    v_exp_f32 v206, v206
    v_mfma_f32_32x32x16_bf16 v[180:195], v[220:223], v[8:11], v[180:195]
    s_waitcnt lgkmcnt(2)
    v_exp_f32 v207, v207
    v_exp_f32 v208, v208
    v_exp_f32 v209, v209
    v_smfmac_f32_32x32x32_bf16 v[36:51], v[224:227], v[196:203], v240
    ds_read_b128 v[220:223], v241 offset:14848
    ds_read_b128 v[224:227], v242 offset:3072
    v_exp_f32 v210, v210
    v_exp_f32 v211, v211
    v_smfmac_f32_32x32x32_bf16 v[52:67], v[232:235], v[196:203], v240
    ds_read_b128 v[232:235], v243 offset:5120
    v_exp_f32 v180, v180
    v_exp_f32 v181, v181
    v_smfmac_f32_32x32x32_bf16 v[36:51], v[228:231], v[204:211], v240
    ds_read_b128 v[228:231], v242 offset:4096
    v_exp_f32 v182, v182
    v_exp_f32 v183, v183
    v_smfmac_f32_32x32x32_bf16 v[52:67], v[236:239], v[204:211], v240
    s_waitcnt lgkmcnt(3)
    ds_read_b128 v[236:239], v244 offset:5120
    v_exp_f32 v184, v184
    v_exp_f32 v185, v185
    s_add_u32 s32, s32, 1
    s_cmp_eq_u32 s32, 3
    s_cselect_b32 s32, 0, s32
    s_add_u32 s31, s31, 1
    s_cmp_eq_u32 s31, 1
    s_cbranch_scc1 L_tryB
    s_cmp_eq_u32 s31, 7
    s_cbranch_scc1 L_B6
L_B6_ret:
    s_waitcnt vmcnt(0)
L_firstB_done:
    s_barrier
    s_cmp_lt_u32 s31, 7
    s_cbranch_scc1 L_loopB
    s_branch L_epi
L_midB:
    s_waitcnt vmcnt(12)
    s_barrier
    s_branch L_backB
L_B6:
    s_waitcnt lgkmcnt(0)
    s_nop 15
    s_lshr_b32 s34, s49, 1
    s_lshl_b32 s35, s34, 2
    s_add_u32 s35, s35, 153616
    s_lshl_b32 s34, s34, 13
    s_add_u32 s34, s34, 122880
    v_add_u32 v248, s34, v254
    v_mov_b32 v251, s35
    s_cmp_eq_u32 s30, 1
    s_cbranch_scc0 L_eB0
    ds_write_b128 v248, v[36:39] offset:0
    ds_write_b128 v248, v[40:43] offset:1024
    ds_write_b128 v248, v[44:47] offset:2048
    ds_write_b128 v248, v[48:51] offset:3072
    ds_write_b128 v248, v[52:55] offset:4096
    ds_write_b128 v248, v[56:59] offset:5120
    ds_write_b128 v248, v[60:63] offset:6144
    s_waitcnt lgkmcnt(0)
    v_mov_b32 v249, 1
    ds_write_b32 v251, v249
    s_waitcnt lgkmcnt(0)
    s_branch L_B6_ret
L_eB0:
    s_mov_b32 s37, 0
L_eBw:
    ds_read_b32 v249, v251
    s_waitcnt lgkmcnt(0)
    v_readfirstlane_b32 s34, v249
    s_cmp_eq_u32 s34, 1
    s_cbranch_scc1 L_eBg
    s_sleep 1
    s_add_u32 s37, s37, 1
    s_cmp_lt_u32 s37, 0x100000
    s_cbranch_scc1 L_eBw
L_eBg:
    ds_read_b128 v[148:151], v248 offset:0
    ds_read_b128 v[152:155], v248 offset:1024
    ds_read_b128 v[156:159], v248 offset:2048
    ds_read_b128 v[160:163], v248 offset:3072
    ds_read_b128 v[164:167], v248 offset:4096
    ds_read_b128 v[168:171], v248 offset:5120
    ds_read_b128 v[172:175], v248 offset:6144
    s_waitcnt lgkmcnt(0)
    v_add_f32 v36, v36, v148
    v_add_f32 v37, v37, v149
    v_add_f32 v38, v38, v150
    v_add_f32 v39, v39, v151
    v_add_f32 v40, v40, v152
    v_add_f32 v41, v41, v153
    v_add_f32 v42, v42, v154
    v_add_f32 v43, v43, v155
    v_add_f32 v44, v44, v156
    v_add_f32 v45, v45, v157
    v_add_f32 v46, v46, v158
    v_add_f32 v47, v47, v159
    v_add_f32 v48, v48, v160
    v_add_f32 v49, v49, v161
    v_add_f32 v50, v50, v162
    v_add_f32 v51, v51, v163
    v_add_f32 v52, v52, v164
    v_add_f32 v53, v53, v165
    v_add_f32 v54, v54, v166
    v_add_f32 v55, v55, v167
    v_add_f32 v56, v56, v168
    v_add_f32 v57, v57, v169
    v_add_f32 v58, v58, v170
    v_add_f32 v59, v59, v171
    v_add_f32 v60, v60, v172
    v_add_f32 v61, v61, v173
    v_add_f32 v62, v62, v174
    v_add_f32 v63, v63, v175
    v_mov_b32 v250, v60
    v_mov_b32 v248, 0
    v_mov_b32 v249, 0
    v_permlane32_swap_b32 v60, v250
    v_pk_fma_f32 v[248:249], v[36:37], 0, v[248:249] op_sel_hi:[1,0,1]
    v_pk_fma_f32 v[248:249], v[38:39], 0, v[248:249] op_sel_hi:[1,0,1]
    v_pk_fma_f32 v[248:249], v[40:41], 0, v[248:249] op_sel_hi:[1,0,1]
    v_pk_fma_f32 v[248:249], v[42:43], 0, v[248:249] op_sel_hi:[1,0,1]
    v_pk_fma_f32 v[248:249], v[44:45], 0, v[248:249] op_sel_hi:[1,0,1]
    v_pk_fma_f32 v[248:249], v[46:47], 0, v[248:249] op_sel_hi:[1,0,1]
    v_pk_fma_f32 v[248:249], v[48:49], 0, v[248:249] op_sel_hi:[1,0,1]
    v_pk_fma_f32 v[248:249], v[50:51], 0, v[248:249] op_sel_hi:[1,0,1]
    v_pk_fma_f32 v[248:249], v[52:53], 0, v[248:249] op_sel_hi:[1,0,1]
    v_pk_fma_f32 v[248:249], v[54:55], 0, v[248:249] op_sel_hi:[1,0,1]
    v_pk_fma_f32 v[248:249], v[56:57], 0, v[248:249] op_sel_hi:[1,0,1]
    v_pk_fma_f32 v[248:249], v[58:59], 0, v[248:249] op_sel_hi:[1,0,1]
    v_cmp_gt_f32 vcc, 0x71800000, v60
    v_add_f32 v248, v248, v249
    s_mov_b64 s[6:7], vcc
    v_cmp_o_f32 vcc, v248, v248
    s_nop 0
    s_and_b64 vcc, vcc, s[6:7]
    s_cmp_eq_u64 vcc, -1
    s_cbranch_scc1 L_fb_retB
    s_mov_b32 s96, 1
    s_branch L_fb
L_fb_retB:
    s_cmp_eq_u32 s98, 1
    s_cbranch_scc0 L_B6_ret
    s_mov_b32 s89, 0
    s_add_u32 s41, s48, s89
    s_add_u32 s34, s28, s41
    s_lshr_b32 s35, s34, 1
    s_and_b32 s36, s34, 1
    s_lshl_b32 s37, s24, 1
    s_add_u32 s36, s36, s37
    s_sub_u32 s37, s24, 28
    s_cmp_eq_u32 s27, 1
    s_cselect_b32 s35, s37, s35
    s_cselect_b32 s36, s34, s36
    s_mul_i32 s90, s36, 28
    s_add_u32 s90, s90, s35
    s_mul_i32 s91, s36, 896
    s_lshl_b32 s35, s35, 3
    s_add_u32 s91, s91, s35
    s_mul_i32 s91, s91, 192
    s_lshl_b32 s90, s90, 12
    s_add_u32 s90, s90, 19267584
    v_mov_b32 v135, s92
    v_mov_b32 v139, s92
    v_mov_b32 v143, s92
    v_mov_b32 v147, s92
    v_mov_b32 v250, v60
    s_nop 1
    v_permlane32_swap_b32 v60, v250
    s_nop 1
    v_rcp_f32 v248, v60
    s_nop 0
    v_pk_mul_f32 v[36:37], v[36:37], v[248:249] op_sel_hi:[1,0]
    v_pk_mul_f32 v[38:39], v[38:39], v[248:249] op_sel_hi:[1,0]
    v_pk_mul_f32 v[40:41], v[40:41], v[248:249] op_sel_hi:[1,0]
    v_pk_mul_f32 v[42:43], v[42:43], v[248:249] op_sel_hi:[1,0]
    v_pk_mul_f32 v[44:45], v[44:45], v[248:249] op_sel_hi:[1,0]
    v_pk_mul_f32 v[46:47], v[46:47], v[248:249] op_sel_hi:[1,0]
    v_pk_mul_f32 v[48:49], v[48:49], v[248:249] op_sel_hi:[1,0]
    v_pk_mul_f32 v[50:51], v[50:51], v[248:249] op_sel_hi:[1,0]
    v_pk_mul_f32 v[52:53], v[52:53], v[248:249] op_sel_hi:[1,0]
    v_pk_mul_f32 v[54:55], v[54:55], v[248:249] op_sel_hi:[1,0]
    v_pk_mul_f32 v[56:57], v[56:57], v[248:249] op_sel_hi:[1,0]
    v_pk_mul_f32 v[58:59], v[58:59], v[248:249] op_sel_hi:[1,0]
    v_cvt_pk_bf16_f32 v132, v36, v37
    v_cvt_pk_bf16_f32 v133, v38, v39
    v_cvt_pk_bf16_f32 v134, v40, v41
    v_cvt_pk_bf16_f32 v136, v42, v43
    v_cvt_pk_bf16_f32 v137, v44, v45
    v_cvt_pk_bf16_f32 v138, v46, v47
    v_cvt_pk_bf16_f32 v140, v48, v49
    v_cvt_pk_bf16_f32 v141, v50, v51
    v_cvt_pk_bf16_f32 v142, v52, v53
    v_cvt_pk_bf16_f32 v144, v54, v55
    v_cvt_pk_bf16_f32 v145, v56, v57
    v_cvt_pk_bf16_f32 v146, v58, v59
    buffer_store_dwordx4 v[132:135], v254, s[20:23], s90 offen offset:0 sc1
    buffer_store_dwordx4 v[136:139], v254, s[20:23], s90 offen offset:1024 sc1
    buffer_store_dwordx4 v[140:143], v254, s[20:23], s90 offen offset:2048 sc1
    buffer_store_dwordx4 v[144:147], v254, s[20:23], s90 offen offset:3072 sc1
    s_branch L_B6_ret
L_tryB:
    s_cmp_eq_u32 s93, 1
    s_cbranch_scc1 L_firstB_done
    s_mov_b32 s94, 4
    s_mov_b32 s95, 0
    s_branch L_pollB
L_firstB:
    s_mov_b32 s94, 0x40000
    s_mov_b32 s95, 1
L_pollB:
    s_lshl_b32 s36, s24, 9
    s_add_u32 s36, s36, 25690112
    v_lshlrev_b32 v248, 7, v247
    s_mov_b32 s37, 0
L_poll:
    s_mov_b64 exec, 15
    buffer_load_dword v249, v248, s[20:23], s36 offen sc1
    s_waitcnt vmcnt(0)
    v_cmp_eq_u32 vcc, s92, v249
    s_mov_b64 exec, -1
    s_cmp_eq_u32 vcc_lo, 15
    s_cbranch_scc1 L_polled
    s_add_u32 s37, s37, 1
    s_cmp_lt_u32 s37, s94
    s_cbranch_scc0 L_giveup
    s_sleep 2
    s_branch L_poll
L_giveup:
    s_cmp_eq_u32 s95, 0
    s_cbranch_scc1 L_firstB_done
L_polled:
    s_lshl_b32 s34, s49, 2
    s_add_u32 s34, s34, 14
    v_and_b32 v248, 15, v247
    v_cmp_eq_u32 vcc, 0, v248
    v_mov_b32 v249, 0x3f803f80
    v_lshlrev_b32 v248, 4, v248
    s_nop 0
    v_cndmask_b32 v176, 0, v249, vcc
    v_cndmask_b32 v177, 0, v249, vcc
    v_cndmask_b32 v178, 0, v249, vcc
    v_cndmask_b32 v179, 0, v249, vcc
    v_lshrrev_b32 v249, 4, v247
    v_add_u32 v249, s34, v249
    v_mul_u32_u24 v250, 6400, v249
    v_add_u32 v250, v250, v248
    v_cmp_gt_u32 vcc, 24, v249
    s_and_saveexec_b64 s[46:47], vcc
    s_cbranch_execz L_pad_2
    ds_write_b128 v250, v[176:179] offset:6144
L_pad_2:
    s_mov_b64 exec, s[46:47]
    s_add_u32 s74, s49, 14
L_first:
    s_add_u32 s34, s74, s28
    s_cmp_ge_u32 s34, 56
    s_cselect_b32 s35, 56, 0
    s_sub_u32 s34, s34, s35
    s_cmp_ge_u32 s74, 24
    s_cselect_b32 s35, 24, 0
    s_sub_u32 s35, s74, s35
    s_cmp_ge_u32 s35, 24
    s_cselect_b32 s36, 24, 0
    s_sub_u32 s35, s35, s36
    s_mul_i32 s36, s34, 6144
    s_add_u32 s36, s36, s40
    s_mul_i32 m0, s35, 6400
    s_nop 0
    buffer_load_dwordx4 v254, s[20:23], s36 offen offset:0 sc1 lds
    buffer_load_dwordx4 v254, s[20:23], s36 offen offset:1024 sc1 lds
    buffer_load_dwordx4 v254, s[20:23], s36 offen offset:2048 sc1 lds
    buffer_load_dwordx4 v254, s[20:23], s36 offen offset:3072 sc1 lds
    s_add_u32 s36, s36, 4096
    s_add_u32 m0, m0, 4096
    s_nop 0
    buffer_load_dwordx4 v254, s[20:23], s36 offen offset:0 sc1 lds
    buffer_load_dwordx4 v254, s[20:23], s36 offen offset:1024 sc1 lds
    s_add_u32 s74, s74, 4
    s_cmp_lt_u32 s74, 24
    s_cbranch_scc1 L_first
    s_waitcnt lgkmcnt(0)
    s_mov_b32 s93, 1
    s_cmp_eq_u32 s95, 0
    s_cbranch_scc1 L_firstB_done
    s_branch L_firstB_ret
L_epi:
    s_setprio 0
    s_cmp_eq_u32 s29, 1
    s_cbranch_scc0 L_eA
    s_cmp_eq_u32 s30, 1
    s_cbranch_scc1 L_done
    s_cmp_eq_u32 s98, 0
    s_cbranch_scc0 L_done
    s_mov_b32 s89, 0
    s_add_u32 s41, s48, s89
    s_add_u32 s34, s28, s41
    s_lshr_b32 s35, s34, 1
    s_and_b32 s36, s34, 1
    s_lshl_b32 s37, s24, 1
    s_add_u32 s36, s36, s37
    s_sub_u32 s37, s24, 28
    s_cmp_eq_u32 s27, 1
    s_cselect_b32 s35, s37, s35
    s_cselect_b32 s36, s34, s36
    s_mul_i32 s90, s36, 28
    s_add_u32 s90, s90, s35
    s_mul_i32 s91, s36, 896
    s_lshl_b32 s35, s35, 3
    s_add_u32 s91, s91, s35
    s_mul_i32 s91, s91, 192
    s_lshl_b32 s90, s90, 12
    s_add_u32 s90, s90, 19267584
    buffer_load_dwordx4 v[132:135], v254, s[20:23], s90 offen offset:0 sc1
    buffer_load_dwordx4 v[136:139], v254, s[20:23], s90 offen offset:1024 sc1
    buffer_load_dwordx4 v[140:143], v254, s[20:23], s90 offen offset:2048 sc1
    buffer_load_dwordx4 v[144:147], v254, s[20:23], s90 offen offset:3072 sc1
    v_mov_b32 v100, v36
    v_mov_b32 v101, v37
    v_mov_b32 v102, v38
    v_mov_b32 v103, v39
    v_mov_b32 v104, v40
    v_mov_b32 v105, v41
    v_mov_b32 v106, v42
    v_mov_b32 v107, v43
    v_mov_b32 v108, v44
    v_mov_b32 v109, v45
    v_mov_b32 v110, v46
    v_mov_b32 v111, v47
    v_mov_b32 v112, v48
    v_mov_b32 v113, v49
    v_mov_b32 v114, v50
    v_mov_b32 v115, v51
    v_mov_b32 v116, v52
    v_mov_b32 v117, v53
    v_mov_b32 v118, v54
    v_mov_b32 v119, v55
    v_mov_b32 v120, v56
    v_mov_b32 v121, v57
    v_mov_b32 v122, v58
    v_mov_b32 v123, v59
    v_mov_b32 v124, v60
    v_mov_b32 v125, v61
    s_mov_b32 s88, 3
    s_branch L_eC
L_eA:
    s_nop 7
    v_mov_b32 v250, v124
    v_mov_b32 v248, 0
    v_mov_b32 v249, 0
    v_permlane32_swap_b32 v124, v250
    v_pk_fma_f32 v[248:249], v[100:101], 0, v[248:249] op_sel_hi:[1,0,1]
    v_pk_fma_f32 v[248:249], v[102:103], 0, v[248:249] op_sel_hi:[1,0,1]
    v_pk_fma_f32 v[248:249], v[104:105], 0, v[248:249] op_sel_hi:[1,0,1]
    v_pk_fma_f32 v[248:249], v[106:107], 0, v[248:249] op_sel_hi:[1,0,1]
    v_pk_fma_f32 v[248:249], v[108:109], 0, v[248:249] op_sel_hi:[1,0,1]
    v_pk_fma_f32 v[248:249], v[110:111], 0, v[248:249] op_sel_hi:[1,0,1]
    v_pk_fma_f32 v[248:249], v[112:113], 0, v[248:249] op_sel_hi:[1,0,1]
    v_pk_fma_f32 v[248:249], v[114:115], 0, v[248:249] op_sel_hi:[1,0,1]
    v_pk_fma_f32 v[248:249], v[116:117], 0, v[248:249] op_sel_hi:[1,0,1]
    v_pk_fma_f32 v[248:249], v[118:119], 0, v[248:249] op_sel_hi:[1,0,1]
    v_pk_fma_f32 v[248:249], v[120:121], 0, v[248:249] op_sel_hi:[1,0,1]
    v_pk_fma_f32 v[248:249], v[122:123], 0, v[248:249] op_sel_hi:[1,0,1]
    v_cmp_gt_f32 vcc, 0x71800000, v124
    v_add_f32 v248, v248, v249
    s_mov_b64 s[6:7], vcc
    v_cmp_o_f32 vcc, v248, v248
    s_nop 0
    s_and_b64 vcc, vcc, s[6:7]
    s_cmp_eq_u64 vcc, -1
    s_cbranch_scc1 L_eA2
    s_or_b32 s96, s96, 4
L_eA2:
    s_cmp_eq_u32 s98, 0
    s_cbranch_scc0 L_eA3
    v_mov_b32 v250, v92
    v_mov_b32 v248, 0
    v_mov_b32 v249, 0
    v_permlane32_swap_b32 v92, v250
    v_pk_fma_f32 v[248:249], v[68:69], 0, v[248:249] op_sel_hi:[1,0,1]
    v_pk_fma_f32 v[248:249], v[70:71], 0, v[248:249] op_sel_hi:[1,0,1]
    v_pk_fma_f32 v[248:249], v[72:73], 0, v[248:249] op_sel_hi:[1,0,1]
    v_pk_fma_f32 v[248:249], v[74:75], 0, v[248:249] op_sel_hi:[1,0,1]
    v_pk_fma_f32 v[248:249], v[76:77], 0, v[248:249] op_sel_hi:[1,0,1]
    v_pk_fma_f32 v[248:249], v[78:79], 0, v[248:249] op_sel_hi:[1,0,1]
    v_pk_fma_f32 v[248:249], v[80:81], 0, v[248:249] op_sel_hi:[1,0,1]
    v_pk_fma_f32 v[248:249], v[82:83], 0, v[248:249] op_sel_hi:[1,0,1]
    v_pk_fma_f32 v[248:249], v[84:85], 0, v[248:249] op_sel_hi:[1,0,1]
    v_pk_fma_f32 v[248:249], v[86:87], 0, v[248:249] op_sel_hi:[1,0,1]
    v_pk_fma_f32 v[248:249], v[88:89], 0, v[248:249] op_sel_hi:[1,0,1]
    v_pk_fma_f32 v[248:249], v[90:91], 0, v[248:249] op_sel_hi:[1,0,1]
    v_cmp_gt_f32 vcc, 0x71800000, v92
    v_add_f32 v248, v248, v249
    s_mov_b64 s[6:7], vcc
    v_cmp_o_f32 vcc, v248, v248
    s_nop 0
    s_and_b64 vcc, vcc, s[6:7]
    s_cmp_eq_u64 vcc, -1
    s_cbranch_scc1 L_eA3
    s_or_b32 s96, s96, 2
L_eA3:
    s_cmp_lg_u32 s96, 0
    s_cbranch_scc1 L_fb
L_fb_retA:
    s_mov_b32 s88, 2
L_eC:
    ds_read_b64_tr_b16 v[164:165], v246 offset:0
    ds_read_b64_tr_b16 v[166:167], v246 offset:1536
    ds_read_b64_tr_b16 v[168:169], v246 offset:64
    ds_read_b64_tr_b16 v[170:171], v246 offset:1600
    ds_read_b64_tr_b16 v[172:173], v246 offset:128
    ds_read_b64_tr_b16 v[174:175], v246 offset:1664
    ds_read_b64_tr_b16 v[176:177], v246 offset:3072
    ds_read_b64_tr_b16 v[178:179], v246 offset:4608
    ds_read_b64_tr_b16 v[180:181], v246 offset:3136
    ds_read_b64_tr_b16 v[182:183], v246 offset:4672
    ds_read_b64_tr_b16 v[184:185], v246 offset:3200
    ds_read_b64_tr_b16 v[186:187], v246 offset:4736
    ds_read_b64_tr_b16 v[188:189], v246 offset:6144
    ds_read_b64_tr_b16 v[190:191], v246 offset:7680
    ds_read_b64_tr_b16 v[192:193], v246 offset:6208
    ds_read_b64_tr_b16 v[194:195], v246 offset:7744
    ds_read_b64_tr_b16 v[196:197], v246 offset:6272
    ds_read_b64_tr_b16 v[198:199], v246 offset:7808
    ds_read_b64_tr_b16 v[200:201], v252 offset:0
    ds_read_b64_tr_b16 v[202:203], v252 offset:1536
    ds_read_b64_tr_b16 v[204:205], v252 offset:64
    ds_read_b64_tr_b16 v[206:207], v252 offset:1600
    ds_read_b64_tr_b16 v[208:209], v252 offset:128
    ds_read_b64_tr_b16 v[210:211], v252 offset:1664
    ds_read_b64_tr_b16 v[212:213], v252 offset:3072
    ds_read_b64_tr_b16 v[214:215], v252 offset:4608
    ds_read_b64_tr_b16 v[216:217], v252 offset:3136
    ds_read_b64_tr_b16 v[218:219], v252 offset:4672
    ds_read_b64_tr_b16 v[220:221], v252 offset:3200
    ds_read_b64_tr_b16 v[222:223], v252 offset:4736
    ds_read_b64_tr_b16 v[224:225], v252 offset:6144
    ds_read_b64_tr_b16 v[226:227], v252 offset:7680
    ds_read_b64_tr_b16 v[228:229], v252 offset:6208
    ds_read_b64_tr_b16 v[230:231], v252 offset:7744
    ds_read_b64_tr_b16 v[232:233], v252 offset:6272
    ds_read_b64_tr_b16 v[234:235], v252 offset:7808
    s_mul_i32 s34, s26, 6144
    v_lshlrev_b32 v248, 2, v247
    v_add_u32 v248, 153856, v248
    ds_read_b32 v240, v248 offset:0
    ds_read_b32 v241, v248 offset:256
    ds_read_b32 v242, v248 offset:512
    ds_read_b32 v243, v248 offset:768
    ds_read_b32 v244, v248 offset:1024
    ds_read_b32 v245, v248 offset:1280
    v_and_b32 v248, 31, v247
    v_mul_u32_u24 v249, 192, v248
    v_lshrrev_b32 v250, 5, v247
    v_lshlrev_b32 v250, 3, v250
    v_add3_u32 v249, v249, v250, s34
    v_bfe_u32 v250, v247, 2, 2
    v_xor_b32 v248, 0, v250
    v_lshl_add_u32 v236, v248, 4, v249
    v_xor_b32 v248, 1, v250
    v_lshl_add_u32 v237, v248, 4, v249
    v_xor_b32 v248, 2, v250
    v_lshl_add_u32 v238, v248, 4, v249
    v_xor_b32 v248, 3, v250
    v_lshl_add_u32 v239, v248, 4, v249
    v_add_u32 v246, s34, v254
    s_mov_b32 s97, 0
    v_mov_b32 v250, v124
    s_nop 1
    v_permlane32_swap_b32 v124, v250
    s_nop 1
    v_rcp_f32 v248, v124
    s_nop 0
    v_pk_mul_f32 v[100:101], v[100:101], v[248:249] op_sel_hi:[1,0]
    v_pk_mul_f32 v[102:103], v[102:103], v[248:249] op_sel_hi:[1,0]
    v_pk_mul_f32 v[104:105], v[104:105], v[248:249] op_sel_hi:[1,0]
    v_pk_mul_f32 v[106:107], v[106:107], v[248:249] op_sel_hi:[1,0]
    v_pk_mul_f32 v[108:109], v[108:109], v[248:249] op_sel_hi:[1,0]
    v_pk_mul_f32 v[110:111], v[110:111], v[248:249] op_sel_hi:[1,0]
    v_pk_mul_f32 v[112:113], v[112:113], v[248:249] op_sel_hi:[1,0]
    v_pk_mul_f32 v[114:115], v[114:115], v[248:249] op_sel_hi:[1,0]
    v_pk_mul_f32 v[116:117], v[116:117], v[248:249] op_sel_hi:[1,0]
    v_pk_mul_f32 v[118:119], v[118:119], v[248:249] op_sel_hi:[1,0]
    v_pk_mul_f32 v[120:121], v[120:121], v[248:249] op_sel_hi:[1,0]
    v_pk_mul_f32 v[122:123], v[122:123], v[248:249] op_sel_hi:[1,0]
    v_cvt_pk_bf16_f32 v48, v100, v101
    v_cvt_pk_bf16_f32 v49, v102, v103
    v_cvt_pk_bf16_f32 v50, v104, v105
    v_cvt_pk_bf16_f32 v51, v106, v107
    v_cvt_pk_bf16_f32 v52, v108, v109
    v_cvt_pk_bf16_f32 v53, v110, v111
    v_cvt_pk_bf16_f32 v54, v112, v113
    v_cvt_pk_bf16_f32 v55, v114, v115
    v_cvt_pk_bf16_f32 v56, v116, v117
    v_cvt_pk_bf16_f32 v57, v118, v119
    v_cvt_pk_bf16_f32 v58, v120, v121
    v_cvt_pk_bf16_f32 v59, v122, v123
    s_sub_u32 s89, 2, s98
    s_cmp_eq_u32 s88, 3
    s_cselect_b32 s89, 0, s89
    s_add_u32 s41, s48, s89
    s_add_u32 s34, s28, s41
    s_lshr_b32 s35, s34, 1
    s_and_b32 s36, s34, 1
    s_lshl_b32 s37, s24, 1
    s_add_u32 s36, s36, s37
    s_sub_u32 s37, s24, 28
    s_cmp_eq_u32 s27, 1
    s_cselect_b32 s35, s37, s35
    s_cselect_b32 s36, s34, s36
    s_mul_i32 s90, s36, 28
    s_add_u32 s90, s90, s35
    s_mul_i32 s91, s36, 896
    s_lshl_b32 s35, s35, 3
    s_add_u32 s91, s91, s35
    s_mul_i32 s91, s91, 192
    s_lshl_b32 s90, s90, 12
    s_add_u32 s90, s90, 19267584
    s_cmp_eq_u32 s88, 2
    s_cbranch_scc0 L_one
    s_cmp_eq_u32 s98, 0
    s_cbranch_scc0 L_one
    s_mov_b32 s99, s90
    s_mov_b32 s100, s91
    s_waitcnt lgkmcnt(0)
    v_mfma_f32_32x32x16_bf16 v[0:15], v[164:167], v[48:51], 0
    v_mfma_f32_32x32x16_bf16 v[16:31], v[168:171], v[48:51], 0
    v_mov_b32 v250, v92
    s_nop 1
    v_permlane32_swap_b32 v92, v250
    s_nop 1
    v_rcp_f32 v248, v92
    s_nop 0
    v_mfma_f32_32x32x16_bf16 v[32:47], v[172:175], v[48:51], 0
    v_pk_mul_f32 v[68:69], v[68:69], v[248:249] op_sel_hi:[1,0]
    v_pk_mul_f32 v[70:71], v[70:71], v[248:249] op_sel_hi:[1,0]
    v_pk_mul_f32 v[72:73], v[72:73], v[248:249] op_sel_hi:[1,0]
    v_pk_mul_f32 v[74:75], v[74:75], v[248:249] op_sel_hi:[1,0]
    v_pk_mul_f32 v[76:77], v[76:77], v[248:249] op_sel_hi:[1,0]
    v_pk_mul_f32 v[78:79], v[78:79], v[248:249] op_sel_hi:[1,0]
    v_mfma_f32_32x32x16_bf16 v[0:15], v[176:179], v[52:55], v[0:15]
    v_pk_mul_f32 v[80:81], v[80:81], v[248:249] op_sel_hi:[1,0]
    v_pk_mul_f32 v[82:83], v[82:83], v[248:249] op_sel_hi:[1,0]
    v_pk_mul_f32 v[84:85], v[84:85], v[248:249] op_sel_hi:[1,0]
    v_pk_mul_f32 v[86:87], v[86:87], v[248:249] op_sel_hi:[1,0]
    v_pk_mul_f32 v[88:89], v[88:89], v[248:249] op_sel_hi:[1,0]
    v_pk_mul_f32 v[90:91], v[90:91], v[248:249] op_sel_hi:[1,0]
    v_mfma_f32_32x32x16_bf16 v[16:31], v[180:183], v[52:55], v[16:31]
    v_cvt_pk_bf16_f32 v100, v68, v69
    v_cvt_pk_bf16_f32 v101, v70, v71
    v_cvt_pk_bf16_f32 v102, v72, v73
    v_cvt_pk_bf16_f32 v103, v74, v75
    v_cvt_pk_bf16_f32 v104, v76, v77
    v_cvt_pk_bf16_f32 v105, v78, v79
    v_mfma_f32_32x32x16_bf16 v[32:47], v[184:187], v[52:55], v[32:47]
    v_cvt_pk_bf16_f32 v106, v80, v81
    v_cvt_pk_bf16_f32 v107, v82, v83
    v_cvt_pk_bf16_f32 v108, v84, v85
    v_cvt_pk_bf16_f32 v109, v86, v87
    v_cvt_pk_bf16_f32 v110, v88, v89
    v_cvt_pk_bf16_f32 v111, v90, v91
    v_mfma_f32_32x32x16_bf16 v[0:15], v[188:191], v[56:59], v[0:15]
    s_lshl_b32 s89, s98, 1
    s_add_u32 s41, s48, s89
    s_add_u32 s34, s28, s41
    s_lshr_b32 s35, s34, 1
    s_and_b32 s36, s34, 1
    s_lshl_b32 s37, s24, 1
    v_mfma_f32_32x32x16_bf16 v[16:31], v[192:195], v[56:59], v[16:31]
    s_add_u32 s36, s36, s37
    s_sub_u32 s37, s24, 28
    s_cmp_eq_u32 s27, 1
    s_cselect_b32 s35, s37, s35
    s_cselect_b32 s36, s34, s36
    s_mul_i32 s90, s36, 28
    v_mfma_f32_32x32x16_bf16 v[32:47], v[196:199], v[56:59], v[32:47]
    s_add_u32 s90, s90, s35
    s_mul_i32 s91, s36, 896
    s_lshl_b32 s35, s35, 3
    s_add_u32 s91, s91, s35
    s_mul_i32 s91, s91, 192
    s_lshl_b32 s90, s90, 12
    s_add_u32 s90, s90, 19267584
    s_waitcnt vmcnt(0)
L_rchka:
    v_cmp_eq_u32 vcc, s92, v135
    v_cmp_eq_u32 s[6:7], s92, v139
    s_and_b64 vcc, vcc, s[6:7]
    v_cmp_eq_u32 s[6:7], s92, v143
    s_and_b64 vcc, vcc, s[6:7]
    v_cmp_eq_u32 s[6:7], s92, v147
    s_and_b64 vcc, vcc, s[6:7]
    s_cmp_eq_u64 vcc, -1
    s_cbranch_scc0 L_rslowa
L_rgota:
    v_mov_b32 v135, v136
    v_mov_b32 v136, v137
    v_mov_b32 v137, v138
    v_mov_b32 v138, v140
    v_mov_b32 v139, v141
    v_mov_b32 v140, v142
    v_mov_b32 v141, v144
    v_mov_b32 v142, v145
    v_mov_b32 v143, v146
    s_nop 1
    v_mfma_f32_32x32x16_bf16 v[0:15], v[200:203], v[132:135], v[0:15]
    v_mfma_f32_32x32x16_bf16 v[16:31], v[204:207], v[132:135], v[16:31]
    v_mfma_f32_32x32x16_bf16 v[32:47], v[208:211], v[132:135], v[32:47]
    v_mfma_f32_32x32x16_bf16 v[0:15], v[212:215], v[136:139], v[0:15]
    v_mfma_f32_32x32x16_bf16 v[16:31], v[216:219], v[136:139], v[16:31]
    v_mfma_f32_32x32x16_bf16 v[32:47], v[220:223], v[136:139], v[32:47]
    v_mfma_f32_32x32x16_bf16 v[0:15], v[224:227], v[140:143], v[0:15]
    v_mfma_f32_32x32x16_bf16 v[16:31], v[228:231], v[140:143], v[16:31]
    v_mfma_f32_32x32x16_bf16 v[32:47], v[232:235], v[140:143], v[32:47]
    v_mfma_f32_32x32x16_bf16 v[112:127], v[164:167], v[100:103], 0
    v_mfma_f32_32x32x16_bf16 v[68:83], v[168:171], v[100:103], 0
    v_mfma_f32_32x32x16_bf16 v[84:99], v[172:175], v[100:103], 0
    v_cvt_pk_bf16_f32 v48, v0, v1
    v_cvt_pk_bf16_f32 v49, v2, v3
    ds_write_b64 v236, v[48:49] offset:0
    v_cvt_pk_bf16_f32 v50, v4, v5
    v_cvt_pk_bf16_f32 v51, v6, v7
    v_mfma_f32_32x32x16_bf16 v[112:127], v[176:179], v[104:107], v[112:127]
    ds_write_b64 v237, v[50:51] offset:0
    v_cvt_pk_bf16_f32 v52, v8, v9
    v_cvt_pk_bf16_f32 v53, v10, v11
    ds_write_b64 v238, v[52:53] offset:0
    v_cvt_pk_bf16_f32 v54, v12, v13
    v_mfma_f32_32x32x16_bf16 v[68:83], v[180:183], v[104:107], v[68:83]
    v_cvt_pk_bf16_f32 v55, v14, v15
    ds_write_b64 v239, v[54:55] offset:0
    v_cvt_pk_bf16_f32 v56, v16, v17
    v_cvt_pk_bf16_f32 v57, v18, v19
    ds_write_b64 v236, v[56:57] offset:64
    v_mfma_f32_32x32x16_bf16 v[84:99], v[184:187], v[104:107], v[84:99]
    v_cvt_pk_bf16_f32 v58, v20, v21
    v_cvt_pk_bf16_f32 v59, v22, v23
    ds_write_b64 v237, v[58:59] offset:64
    v_cvt_pk_bf16_f32 v60, v24, v25
    v_cvt_pk_bf16_f32 v61, v26, v27
    v_mfma_f32_32x32x16_bf16 v[112:127], v[188:191], v[108:111], v[112:127]
    ds_write_b64 v238, v[60:61] offset:64
    v_cvt_pk_bf16_f32 v62, v28, v29
    v_cvt_pk_bf16_f32 v63, v30, v31
    ds_write_b64 v239, v[62:63] offset:64
    v_cvt_pk_bf16_f32 v132, v32, v33
    v_mfma_f32_32x32x16_bf16 v[68:83], v[192:195], v[108:111], v[68:83]
    v_cvt_pk_bf16_f32 v133, v34, v35
    ds_write_b64 v236, v[132:133] offset:128
    v_cvt_pk_bf16_f32 v134, v36, v37
    v_cvt_pk_bf16_f32 v135, v38, v39
    ds_write_b64 v237, v[134:135] offset:128
    v_mfma_f32_32x32x16_bf16 v[84:99], v[196:199], v[108:111], v[84:99]
    v_cvt_pk_bf16_f32 v136, v40, v41
    v_cvt_pk_bf16_f32 v137, v42, v43
    ds_write_b64 v238, v[136:137] offset:128
    v_cvt_pk_bf16_f32 v138, v44, v45
    v_cvt_pk_bf16_f32 v139, v46, v47
    ds_write_b64 v239, v[138:139] offset:128
L_rchkb:
    v_cmp_eq_u32 vcc, s92, v151
    v_cmp_eq_u32 s[6:7], s92, v155
    s_and_b64 vcc, vcc, s[6:7]
    v_cmp_eq_u32 s[6:7], s92, v159
    s_and_b64 vcc, vcc, s[6:7]
    v_cmp_eq_u32 s[6:7], s92, v163
    s_and_b64 vcc, vcc, s[6:7]
    s_cmp_eq_u64 vcc, -1
    s_cbranch_scc0 L_rslowb
L_rgotb:
    v_mov_b32 v151, v152
    v_mov_b32 v152, v153
    v_mov_b32 v153, v154
    v_mov_b32 v154, v156
    v_mov_b32 v155, v157
    v_mov_b32 v156, v158
    v_mov_b32 v157, v160
    v_mov_b32 v158, v161
    v_mov_b32 v159, v162
    s_nop 1
    v_mfma_f32_32x32x16_bf16 v[112:127], v[200:203], v[148:151], v[112:127]
    v_mfma_f32_32x32x16_bf16 v[68:83], v[204:207], v[148:151], v[68:83]
    ds_read_b128 v[164:167], v246 offset:0
    v_mfma_f32_32x32x16_bf16 v[84:99], v[208:211], v[148:151], v[84:99]
    ds_read_b128 v[168:171], v246 offset:1024
    ds_read_b128 v[172:175], v246 offset:2048
    v_mfma_f32_32x32x16_bf16 v[112:127], v[212:215], v[152:155], v[112:127]
    ds_read_b128 v[176:179], v246 offset:3072
    v_mfma_f32_32x32x16_bf16 v[68:83], v[216:219], v[152:155], v[68:83]
    ds_read_b128 v[180:183], v246 offset:4096
    ds_read_b128 v[184:187], v246 offset:5120
    v_mfma_f32_32x32x16_bf16 v[84:99], v[220:223], v[152:155], v[84:99]
    s_waitcnt lgkmcnt(0)
    buffer_store_dwordx4 v[164:167], v240, s[80:83], s100 offen sc0 sc1
    v_mfma_f32_32x32x16_bf16 v[112:127], v[224:227], v[156:159], v[112:127]
    buffer_store_dwordx4 v[168:171], v241, s[80:83], s100 offen sc0 sc1
    v_mfma_f32_32x32x16_bf16 v[68:83], v[228:231], v[156:159], v[68:83]
    buffer_store_dwordx4 v[172:175], v242, s[80:83], s100 offen sc0 sc1
    buffer_store_dwordx4 v[176:179], v243, s[80:83], s100 offen sc0 sc1
    v_mfma_f32_32x32x16_bf16 v[84:99], v[232:235], v[156:159], v[84:99]
    buffer_store_dwordx4 v[180:183], v244, s[80:83], s100 offen sc0 sc1
    buffer_store_dwordx4 v[184:187], v245, s[80:83], s100 offen sc0 sc1
    s_nop 7
    v_cvt_pk_bf16_f32 v48, v112, v113
    v_cvt_pk_bf16_f32 v49, v114, v115
    ds_write_b64 v236, v[48:49] offset:0
    v_cvt_pk_bf16_f32 v50, v116, v117
    v_cvt_pk_bf16_f32 v51, v118, v119
    ds_write_b64 v237, v[50:51] offset:0
    v_cvt_pk_bf16_f32 v52, v120, v121
    v_cvt_pk_bf16_f32 v53, v122, v123
    ds_write_b64 v238, v[52:53] offset:0
    v_cvt_pk_bf16_f32 v54, v124, v125
    v_cvt_pk_bf16_f32 v55, v126, v127
    ds_write_b64 v239, v[54:55] offset:0
    v_cvt_pk_bf16_f32 v56, v68, v69
    v_cvt_pk_bf16_f32 v57, v70, v71
    ds_write_b64 v236, v[56:57] offset:64
    v_cvt_pk_bf16_f32 v58, v72, v73
    v_cvt_pk_bf16_f32 v59, v74, v75
    ds_write_b64 v237, v[58:59] offset:64
    v_cvt_pk_bf16_f32 v60, v76, v77
    v_cvt_pk_bf16_f32 v61, v78, v79
    ds_write_b64 v238, v[60:61] offset:64
    v_cvt_pk_bf16_f32 v62, v80, v81
    v_cvt_pk_bf16_f32 v63, v82, v83
    ds_write_b64 v239, v[62:63] offset:64
    v_cvt_pk_bf16_f32 v132, v84, v85
    v_cvt_pk_bf16_f32 v133, v86, v87
    ds_write_b64 v236, v[132:133] offset:128
    v_cvt_pk_bf16_f32 v134, v88, v89
    v_cvt_pk_bf16_f32 v135, v90, v91
    ds_write_b64 v237, v[134:135] offset:128
    v_cvt_pk_bf16_f32 v136, v92, v93
    v_cvt_pk_bf16_f32 v137, v94, v95
    ds_write_b64 v238, v[136:137] offset:128
    v_cvt_pk_bf16_f32 v138, v96, v97
    v_cvt_pk_bf16_f32 v139, v98, v99
    ds_write_b64 v239, v[138:139] offset:128
    s_waitcnt lgkmcnt(0)
    ds_read_b128 v[188:191], v246 offset:0
    ds_read_b128 v[192:195], v246 offset:1024
    ds_read_b128 v[196:199], v246 offset:2048
    ds_read_b128 v[200:203], v246 offset:3072
    ds_read_b128 v[204:207], v246 offset:4096
    ds_read_b128 v[208:211], v246 offset:5120
    s_waitcnt lgkmcnt(0)
    buffer_store_dwordx4 v[188:191], v240, s[80:83], s91 offen sc0 sc1
    buffer_store_dwordx4 v[192:195], v241, s[80:83], s91 offen sc0 sc1
    buffer_store_dwordx4 v[196:199], v242, s[80:83], s91 offen sc0 sc1
    buffer_store_dwordx4 v[200:203], v243, s[80:83], s91 offen sc0 sc1
    buffer_store_dwordx4 v[204:207], v244, s[80:83], s91 offen sc0 sc1
    buffer_store_dwordx4 v[208:211], v245, s[80:83], s91 offen sc0 sc1
    s_branch L_done
L_one:
    s_waitcnt lgkmcnt(0)
    v_mfma_f32_32x32x16_bf16 v[0:15], v[164:167], v[48:51], 0
    v_mfma_f32_32x32x16_bf16 v[16:31], v[168:171], v[48:51], 0
    v_mfma_f32_32x32x16_bf16 v[32:47], v[172:175], v[48:51], 0
    v_mfma_f32_32x32x16_bf16 v[0:15], v[176:179], v[52:55], v[0:15]
    v_mfma_f32_32x32x16_bf16 v[16:31], v[180:183], v[52:55], v[16:31]
    v_mfma_f32_32x32x16_bf16 v[32:47], v[184:187], v[52:55], v[32:47]
    v_mfma_f32_32x32x16_bf16 v[0:15], v[188:191], v[56:59], v[0:15]
    v_mfma_f32_32x32x16_bf16 v[16:31], v[192:195], v[56:59], v[16:31]
    v_mfma_f32_32x32x16_bf16 v[32:47], v[196:199], v[56:59], v[32:47]
    s_waitcnt vmcnt(0)
L_rchkc:
    v_cmp_eq_u32 vcc, s92, v135
    v_cmp_eq_u32 s[6:7], s92, v139
    s_and_b64 vcc, vcc, s[6:7]
    v_cmp_eq_u32 s[6:7], s92, v143
    s_and_b64 vcc, vcc, s[6:7]
    v_cmp_eq_u32 s[6:7], s92, v147
    s_and_b64 vcc, vcc, s[6:7]
    s_cmp_eq_u64 vcc, -1
    s_cbranch_scc0 L_rslowc
L_rgotc:
    v_mov_b32 v135, v136
    v_mov_b32 v136, v137
    v_mov_b32 v137, v138
    v_mov_b32 v138, v140
    v_mov_b32 v139, v141
    v_mov_b32 v140, v142
    v_mov_b32 v141, v144
    v_mov_b32 v142, v145
    v_mov_b32 v143, v146
    s_nop 1
    v_mfma_f32_32x32x16_bf16 v[0:15], v[200:203], v[132:135], v[0:15]
    v_mfma_f32_32x32x16_bf16 v[16:31], v[204:207], v[132:135], v[16:31]
    v_mfma_f32_32x32x16_bf16 v[32:47], v[208:211], v[132:135], v[32:47]
    v_mfma_f32_32x32x16_bf16 v[0:15], v[212:215], v[136:139], v[0:15]
    v_mfma_f32_32x32x16_bf16 v[16:31], v[216:219], v[136:139], v[16:31]
    v_mfma_f32_32x32x16_bf16 v[32:47], v[220:223], v[136:139], v[32:47]
    v_mfma_f32_32x32x16_bf16 v[0:15], v[224:227], v[140:143], v[0:15]
    v_mfma_f32_32x32x16_bf16 v[16:31], v[228:231], v[140:143], v[16:31]
    v_mfma_f32_32x32x16_bf16 v[32:47], v[232:235], v[140:143], v[32:47]
    s_nop 7
    v_cvt_pk_bf16_f32 v48, v0, v1
    v_cvt_pk_bf16_f32 v49, v2, v3
    ds_write_b64 v236, v[48:49] offset:0
    v_cvt_pk_bf16_f32 v50, v4, v5
    v_cvt_pk_bf16_f32 v51, v6, v7
    ds_write_b64 v237, v[50:51] offset:0
    v_cvt_pk_bf16_f32 v52, v8, v9
    v_cvt_pk_bf16_f32 v53, v10, v11
    ds_write_b64 v238, v[52:53] offset:0
    v_cvt_pk_bf16_f32 v54, v12, v13
    v_cvt_pk_bf16_f32 v55, v14, v15
    ds_write_b64 v239, v[54:55] offset:0
    v_cvt_pk_bf16_f32 v56, v16, v17
    v_cvt_pk_bf16_f32 v57, v18, v19
    ds_write_b64 v236, v[56:57] offset:64
    v_cvt_pk_bf16_f32 v58, v20, v21
    v_cvt_pk_bf16_f32 v59, v22, v23
    ds_write_b64 v237, v[58:59] offset:64
    v_cvt_pk_bf16_f32 v60, v24, v25
    v_cvt_pk_bf16_f32 v61, v26, v27
    ds_write_b64 v238, v[60:61] offset:64
    v_cvt_pk_bf16_f32 v62, v28, v29
    v_cvt_pk_bf16_f32 v63, v30, v31
    ds_write_b64 v239, v[62:63] offset:64
    v_cvt_pk_bf16_f32 v132, v32, v33
    v_cvt_pk_bf16_f32 v133, v34, v35
    ds_write_b64 v236, v[132:133] offset:128
    v_cvt_pk_bf16_f32 v134, v36, v37
    v_cvt_pk_bf16_f32 v135, v38, v39
    ds_write_b64 v237, v[134:135] offset:128
    v_cvt_pk_bf16_f32 v136, v40, v41
    v_cvt_pk_bf16_f32 v137, v42, v43
    ds_write_b64 v238, v[136:137] offset:128
    v_cvt_pk_bf16_f32 v138, v44, v45
    v_cvt_pk_bf16_f32 v139, v46, v47
    ds_write_b64 v239, v[138:139] offset:128
    s_waitcnt lgkmcnt(0)
    ds_read_b128 v[164:167], v246 offset:0
    ds_read_b128 v[168:171], v246 offset:1024
    ds_read_b128 v[172:175], v246 offset:2048
    ds_read_b128 v[176:179], v246 offset:3072
    ds_read_b128 v[180:183], v246 offset:4096
    ds_read_b128 v[184:187], v246 offset:5120
    s_waitcnt lgkmcnt(0)
    buffer_store_dwordx4 v[164:167], v240, s[80:83], s91 offen sc0 sc1
    buffer_store_dwordx4 v[168:171], v241, s[80:83], s91 offen sc0 sc1
    buffer_store_dwordx4 v[172:175], v242, s[80:83], s91 offen sc0 sc1
    buffer_store_dwordx4 v[176:179], v243, s[80:83], s91 offen sc0 sc1
    buffer_store_dwordx4 v[180:183], v244, s[80:83], s91 offen sc0 sc1
    buffer_store_dwordx4 v[184:187], v245, s[80:83], s91 offen sc0 sc1
    s_branch L_done
L_rslowa:
    s_add_u32 s97, s97, 1
    s_cmp_lt_u32 s97, 0x40000
    s_cbranch_scc0 L_rgota
    s_cmp_le_u32 s97, 2
    s_cbranch_scc1 L_rfulla
    v_mov_b32 v249, 4092
L_rpolla:
    s_mov_b64 exec, 1
    buffer_load_dword v250, v249, s[20:23], s99 offen sc1
    s_waitcnt vmcnt(0)
    s_mov_b64 exec, -1
    v_readfirstlane_b32 s34, v250
    s_cmp_eq_u32 s34, s92
    s_cbranch_scc1 L_rfulla
    s_sleep 2
    s_add_u32 s97, s97, 1
    s_cmp_lt_u32 s97, 0x40000
    s_cbranch_scc1 L_rpolla
L_rfulla:
    buffer_load_dwordx4 v[132:135], v254, s[20:23], s99 offen offset:0 sc1
    buffer_load_dwordx4 v[136:139], v254, s[20:23], s99 offen offset:1024 sc1
    buffer_load_dwordx4 v[140:143], v254, s[20:23], s99 offen offset:2048 sc1
    buffer_load_dwordx4 v[144:147], v254, s[20:23], s99 offen offset:3072 sc1
    s_waitcnt vmcnt(0)
    s_branch L_rchka
L_rslowb:
    s_add_u32 s97, s97, 1
    s_cmp_lt_u32 s97, 0x40000
    s_cbranch_scc0 L_rgotb
    s_cmp_le_u32 s97, 2
    s_cbranch_scc1 L_rfullb
    v_mov_b32 v249, 4092
L_rpollb:
    s_mov_b64 exec, 1
    buffer_load_dword v250, v249, s[20:23], s90 offen sc1
    s_waitcnt vmcnt(0)
    s_mov_b64 exec, -1
    v_readfirstlane_b32 s34, v250
    s_cmp_eq_u32 s34, s92
    s_cbranch_scc1 L_rfullb
    s_sleep 2
    s_add_u32 s97, s97, 1
    s_cmp_lt_u32 s97, 0x40000
    s_cbranch_scc1 L_rpollb
L_rfullb:
    buffer_load_dwordx4 v[148:151], v254, s[20:23], s90 offen offset:0 sc1
    buffer_load_dwordx4 v[152:155], v254, s[20:23], s90 offen offset:1024 sc1
    buffer_load_dwordx4 v[156:159], v254, s[20:23], s90 offen offset:2048 sc1
    buffer_load_dwordx4 v[160:163], v254, s[20:23], s90 offen offset:3072 sc1
    s_waitcnt vmcnt(0)
    s_branch L_rchkb
L_rslowc:
    s_add_u32 s97, s97, 1
    s_cmp_lt_u32 s97, 0x40000
    s_cbranch_scc0 L_rgotc
    s_cmp_le_u32 s97, 2
    s_cbranch_scc1 L_rfullc
    v_mov_b32 v249, 4092
L_rpollc:
    s_mov_b64 exec, 1
    buffer_load_dword v250, v249, s[20:23], s90 offen sc1
    s_waitcnt vmcnt(0)
    s_mov_b64 exec, -1
    v_readfirstlane_b32 s34, v250
    s_cmp_eq_u32 s34, s92
    s_cbranch_scc1 L_rfullc
    s_sleep 2
    s_add_u32 s97, s97, 1
    s_cmp_lt_u32 s97, 0x40000
    s_cbranch_scc1 L_rpollc
L_rfullc:
    buffer_load_dwordx4 v[132:135], v254, s[20:23], s90 offen offset:0 sc1
    buffer_load_dwordx4 v[136:139], v254, s[20:23], s90 offen offset:1024 sc1
    buffer_load_dwordx4 v[140:143], v254, s[20:23], s90 offen offset:2048 sc1
    buffer_load_dwordx4 v[144:147], v254, s[20:23], s90 offen offset:3072 sc1
    s_waitcnt vmcnt(0)
    s_branch L_rchkc
L_fb:
    s_bitcmp1_b32 s96, 0
    s_cbranch_scc0 L_fbn0
    v_mov_b32 v36, 0
    v_mov_b32 v37, 0
    v_mov_b32 v38, 0
    v_mov_b32 v39, 0
    v_mov_b32 v40, 0
    v_mov_b32 v41, 0
    v_mov_b32 v42, 0
    v_mov_b32 v43, 0
    v_mov_b32 v44, 0
    v_mov_b32 v45, 0
    v_mov_b32 v46, 0
    v_mov_b32 v47, 0
    v_mov_b32 v48, 0
    v_mov_b32 v49, 0
    v_mov_b32 v50, 0
    v_mov_b32 v51, 0
    v_mov_b32 v52, 0
    v_mov_b32 v53, 0
    v_mov_b32 v54, 0
    v_mov_b32 v55, 0
    v_mov_b32 v56, 0
    v_mov_b32 v57, 0
    v_mov_b32 v58, 0
    v_mov_b32 v59, 0
    v_mov_b32 v60, 0
    v_mov_b32 v61, 0
    v_mov_b32 v62, 0
    v_mov_b32 v63, 0
    v_mov_b32 v64, 0
    v_mov_b32 v65, 0
    v_mov_b32 v66, 0
    v_mov_b32 v67, 0
    v_mov_b32 v180, 0xff7fffff
    v_and_b32 v248, 31, v247
    v_cmp_eq_u32 vcc, 16, v248
    v_mov_b32 v249, 0x3f803f80
    s_nop 1
    v_cndmask_b32 v232, 0, v249, vcc
    v_cndmask_b32 v233, 0, v249, vcc
    v_cndmask_b32 v234, 0, v249, vcc
    v_cndmask_b32 v235, 0, v249, vcc
    v_cndmask_b32 v236, 0, v249, vcc
    v_cndmask_b32 v237, 0, v249, vcc
    v_cndmask_b32 v238, 0, v249, vcc
    v_cndmask_b32 v239, 0, v249, vcc
    v_lshrrev_b32 v183, 5, v247
    v_lshlrev_b32 v183, 8, v183
    v_and_b32 v184, 15, v247
    v_lshlrev_b32 v184, 4, v184
    v_add_u32 v183, v183, v184
    s_mov_b32 s99, 0
    s_mov_b32 s100, s40
L_fb0:
    s_add_u32 s101, s100, 4096
    buffer_load_dwordx4 v[212:215], v254, s[20:23], s100 offen offset:0 sc1
    buffer_load_dwordx4 v[216:219], v254, s[20:23], s100 offen offset:1024 sc1
    buffer_load_dwordx4 v[220:223], v254, s[20:23], s100 offen offset:2048 sc1
    buffer_load_dwordx4 v[224:227], v254, s[20:23], s100 offen offset:3072 sc1
    buffer_load_dwordx4 v[228:231], v254, s[20:23], s101 offen sc1
    s_mov_b32 s6, 0x0000ffff
    s_mov_b32 s7, 0x0000ffff
    s_mov_b64 exec, s[6:7]
    buffer_load_dwordx4 v[232:235], v183, s[20:23], s101 offen offset:1024 sc1
    buffer_load_dwordx4 v[236:239], v183, s[20:23], s101 offen offset:1536 sc1
    s_mov_b64 exec, -1
    s_waitcnt vmcnt(0)
    v_mfma_f32_32x32x16_bf16 v[164:179], v[212:215], v[0:3], 0
    v_mfma_f32_32x32x16_bf16 v[164:179], v[216:219], v[4:7], v[164:179]
    v_mfma_f32_32x32x16_bf16 v[164:179], v[220:223], v[8:11], v[164:179]
    s_nop 15
    s_nop 3
    v_max3_f32 v181, v164, v165, v166
    v_max3_f32 v181, v181, v167, v168
    v_max3_f32 v181, v181, v169, v170
    v_max3_f32 v181, v181, v171, v172
    v_max3_f32 v181, v181, v173, v174
    v_max3_f32 v181, v181, v175, v176
    v_max3_f32 v181, v181, v177, v178
    v_max3_f32 v181, v181, v179, v180
    v_mov_b32 v182, v181
    s_nop 1
    v_permlane32_swap_b32 v181, v182
    s_nop 1
    v_max_f32 v181, v181, v182
    v_sub_f32 v182, v180, v181
    v_exp_f32 v182, v182
    v_mov_b32 v180, v181
    v_sub_f32 v164, v164, v181
    v_sub_f32 v165, v165, v181
    v_sub_f32 v166, v166, v181
    v_sub_f32 v167, v167, v181
    v_sub_f32 v168, v168, v181
    v_sub_f32 v169, v169, v181
    v_sub_f32 v170, v170, v181
    v_sub_f32 v171, v171, v181
    v_sub_f32 v172, v172, v181
    v_sub_f32 v173, v173, v181
    v_sub_f32 v174, v174, v181
    v_sub_f32 v175, v175, v181
    v_sub_f32 v176, v176, v181
    v_sub_f32 v177, v177, v181
    v_sub_f32 v178, v178, v181
    v_sub_f32 v179, v179, v181
    v_exp_f32 v164, v164
    v_exp_f32 v165, v165
    v_exp_f32 v166, v166
    v_exp_f32 v167, v167
    v_exp_f32 v168, v168
    v_exp_f32 v169, v169
    v_exp_f32 v170, v170
    v_exp_f32 v171, v171
    v_exp_f32 v172, v172
    v_exp_f32 v173, v173
    v_exp_f32 v174, v174
    v_exp_f32 v175, v175
    v_exp_f32 v176, v176
    v_exp_f32 v177, v177
    v_exp_f32 v178, v178
    v_exp_f32 v179, v179
    v_mul_f32 v36, v36, v182
    v_mul_f32 v37, v37, v182
    v_mul_f32 v38, v38, v182
    v_mul_f32 v39, v39, v182
    v_mul_f32 v40, v40, v182
    v_mul_f32 v41, v41, v182
    v_mul_f32 v42, v42, v182
    v_mul_f32 v43, v43, v182
    v_mul_f32 v44, v44, v182
    v_mul_f32 v45, v45, v182
    v_mul_f32 v46, v46, v182
    v_mul_f32 v47, v47, v182
    v_mul_f32 v48, v48, v182
    v_mul_f32 v49, v49, v182
    v_mul_f32 v50, v50, v182
    v_mul_f32 v51, v51, v182
    v_mul_f32 v52, v52, v182
    v_mul_f32 v53, v53, v182
    v_mul_f32 v54, v54, v182
    v_mul_f32 v55, v55, v182
    v_mul_f32 v56, v56, v182
    v_mul_f32 v57, v57, v182
    v_mul_f32 v58, v58, v182
    v_mul_f32 v59, v59, v182
    v_mul_f32 v60, v60, v182
    v_mul_f32 v61, v61, v182
    v_mul_f32 v62, v62, v182
    v_mul_f32 v63, v63, v182
    v_mul_f32 v64, v64, v182
    v_mul_f32 v65, v65, v182
    v_mul_f32 v66, v66, v182
    v_mul_f32 v67, v67, v182
    s_nop 1
    v_smfmac_f32_32x32x32_bf16 v[36:51], v[224:227], v[164:171], v240
    v_smfmac_f32_32x32x32_bf16 v[52:67], v[232:235], v[164:171], v240
    v_smfmac_f32_32x32x32_bf16 v[36:51], v[228:231], v[172:179], v240
    v_smfmac_f32_32x32x32_bf16 v[52:67], v[236:239], v[172:179], v240
    s_nop 15
    s_nop 3
    s_add_u32 s100, s100, 6144
    s_add_u32 s99, s99, 1
    s_cmp_lt_u32 s99, 56
    s_cbranch_scc1 L_fb0
    s_cmp_eq_u32 s29, 1
    s_cbranch_scc1 L_fb_retB
    s_sub_u32 s89, 1, s98
    s_add_u32 s41, s48, s89
    s_add_u32 s34, s28, s41
    s_lshr_b32 s35, s34, 1
    s_and_b32 s36, s34, 1
    s_lshl_b32 s37, s24, 1
    s_add_u32 s36, s36, s37
    s_sub_u32 s37, s24, 28
    s_cmp_eq_u32 s27, 1
    s_cselect_b32 s35, s37, s35
    s_cselect_b32 s36, s34, s36
    s_mul_i32 s90, s36, 28
    s_add_u32 s90, s90, s35
    s_mul_i32 s91, s36, 896
    s_lshl_b32 s35, s35, 3
    s_add_u32 s91, s91, s35
    s_mul_i32 s91, s91, 192
    s_lshl_b32 s90, s90, 12
    s_add_u32 s90, s90, 19267584
    v_mov_b32 v167, s92
    v_mov_b32 v171, s92
    v_mov_b32 v175, s92
    v_mov_b32 v179, s92
    v_mov_b32 v250, v60
    s_nop 1
    v_permlane32_swap_b32 v60, v250
    s_nop 1
    v_rcp_f32 v248, v60
    s_nop 0
    v_pk_mul_f32 v[36:37], v[36:37], v[248:249] op_sel_hi:[1,0]
    v_pk_mul_f32 v[38:39], v[38:39], v[248:249] op_sel_hi:[1,0]
    v_pk_mul_f32 v[40:41], v[40:41], v[248:249] op_sel_hi:[1,0]
    v_pk_mul_f32 v[42:43], v[42:43], v[248:249] op_sel_hi:[1,0]
    v_pk_mul_f32 v[44:45], v[44:45], v[248:249] op_sel_hi:[1,0]
    v_pk_mul_f32 v[46:47], v[46:47], v[248:249] op_sel_hi:[1,0]
    v_pk_mul_f32 v[48:49], v[48:49], v[248:249] op_sel_hi:[1,0]
    v_pk_mul_f32 v[50:51], v[50:51], v[248:249] op_sel_hi:[1,0]
    v_pk_mul_f32 v[52:53], v[52:53], v[248:249] op_sel_hi:[1,0]
    v_pk_mul_f32 v[54:55], v[54:55], v[248:249] op_sel_hi:[1,0]
    v_pk_mul_f32 v[56:57], v[56:57], v[248:249] op_sel_hi:[1,0]
    v_pk_mul_f32 v[58:59], v[58:59], v[248:249] op_sel_hi:[1,0]
    v_cvt_pk_bf16_f32 v164, v36, v37
    v_cvt_pk_bf16_f32 v165, v38, v39
    v_cvt_pk_bf16_f32 v166, v40, v41
    v_cvt_pk_bf16_f32 v168, v42, v43
    v_cvt_pk_bf16_f32 v169, v44, v45
    v_cvt_pk_bf16_f32 v170, v46, v47
    v_cvt_pk_bf16_f32 v172, v48, v49
    v_cvt_pk_bf16_f32 v173, v50, v51
    v_cvt_pk_bf16_f32 v174, v52, v53
    v_cvt_pk_bf16_f32 v176, v54, v55
    v_cvt_pk_bf16_f32 v177, v56, v57
    v_cvt_pk_bf16_f32 v178, v58, v59
    buffer_store_dwordx4 v[164:167], v254, s[20:23], s90 offen offset:0 sc1
    buffer_store_dwordx4 v[168:171], v254, s[20:23], s90 offen offset:1024 sc1
    buffer_store_dwordx4 v[172:175], v254, s[20:23], s90 offen offset:2048 sc1
    buffer_store_dwordx4 v[176:179], v254, s[20:23], s90 offen offset:3072 sc1
L_fbn0:
    s_bitcmp1_b32 s96, 1
    s_cbranch_scc0 L_fbn1
    v_mov_b32 v68, 0
    v_mov_b32 v69, 0
    v_mov_b32 v70, 0
    v_mov_b32 v71, 0
    v_mov_b32 v72, 0
    v_mov_b32 v73, 0
    v_mov_b32 v74, 0
    v_mov_b32 v75, 0
    v_mov_b32 v76, 0
    v_mov_b32 v77, 0
    v_mov_b32 v78, 0
    v_mov_b32 v79, 0
    v_mov_b32 v80, 0
    v_mov_b32 v81, 0
    v_mov_b32 v82, 0
    v_mov_b32 v83, 0
    v_mov_b32 v84, 0
    v_mov_b32 v85, 0
    v_mov_b32 v86, 0
    v_mov_b32 v87, 0
    v_mov_b32 v88, 0
    v_mov_b32 v89, 0
    v_mov_b32 v90, 0
    v_mov_b32 v91, 0
    v_mov_b32 v92, 0
    v_mov_b32 v93, 0
    v_mov_b32 v94, 0
    v_mov_b32 v95, 0
    v_mov_b32 v96, 0
    v_mov_b32 v97, 0
    v_mov_b32 v98, 0
    v_mov_b32 v99, 0
    v_mov_b32 v180, 0xff7fffff
    v_and_b32 v248, 31, v247
    v_cmp_eq_u32 vcc, 16, v248
    v_mov_b32 v249, 0x3f803f80
    s_nop 1
    v_cndmask_b32 v232, 0, v249, vcc
    v_cndmask_b32 v233, 0, v249, vcc
    v_cndmask_b32 v234, 0, v249, vcc
    v_cndmask_b32 v235, 0, v249, vcc
    v_cndmask_b32 v236, 0, v249, vcc
    v_cndmask_b32 v237, 0, v249, vcc
    v_cndmask_b32 v238, 0, v249, vcc
    v_cndmask_b32 v239, 0, v249, vcc
    v_lshrrev_b32 v183, 5, v247
    v_lshlrev_b32 v183, 8, v183
    v_and_b32 v184, 15, v247
    v_lshlrev_b32 v184, 4, v184
    v_add_u32 v183, v183, v184
    s_mov_b32 s99, 0
    s_mov_b32 s100, s40
L_fb1:
    s_add_u32 s101, s100, 4096
    buffer_load_dwordx4 v[212:215], v254, s[20:23], s100 offen offset:0 sc1
    buffer_load_dwordx4 v[216:219], v254, s[20:23], s100 offen offset:1024 sc1
    buffer_load_dwordx4 v[220:223], v254, s[20:23], s100 offen offset:2048 sc1
    buffer_load_dwordx4 v[224:227], v254, s[20:23], s100 offen offset:3072 sc1
    buffer_load_dwordx4 v[228:231], v254, s[20:23], s101 offen sc1
    s_mov_b32 s6, 0x0000ffff
    s_mov_b32 s7, 0x0000ffff
    s_mov_b64 exec, s[6:7]
    buffer_load_dwordx4 v[232:235], v183, s[20:23], s101 offen offset:1024 sc1
    buffer_load_dwordx4 v[236:239], v183, s[20:23], s101 offen offset:1536 sc1
    s_mov_b64 exec, -1
    s_waitcnt vmcnt(0)
    v_mfma_f32_32x32x16_bf16 v[164:179], v[212:215], v[12:15], 0
    v_mfma_f32_32x32x16_bf16 v[164:179], v[216:219], v[16:19], v[164:179]
    v_mfma_f32_32x32x16_bf16 v[164:179], v[220:223], v[20:23], v[164:179]
    s_nop 15
    s_nop 3
    v_max3_f32 v181, v164, v165, v166
    v_max3_f32 v181, v181, v167, v168
    v_max3_f32 v181, v181, v169, v170
    v_max3_f32 v181, v181, v171, v172
    v_max3_f32 v181, v181, v173, v174
    v_max3_f32 v181, v181, v175, v176
    v_max3_f32 v181, v181, v177, v178
    v_max3_f32 v181, v181, v179, v180
    v_mov_b32 v182, v181
    s_nop 1
    v_permlane32_swap_b32 v181, v182
    s_nop 1
    v_max_f32 v181, v181, v182
    v_sub_f32 v182, v180, v181
    v_exp_f32 v182, v182
    v_mov_b32 v180, v181
    v_sub_f32 v164, v164, v181
    v_sub_f32 v165, v165, v181
    v_sub_f32 v166, v166, v181
    v_sub_f32 v167, v167, v181
    v_sub_f32 v168, v168, v181
    v_sub_f32 v169, v169, v181
    v_sub_f32 v170, v170, v181
    v_sub_f32 v171, v171, v181
    v_sub_f32 v172, v172, v181
    v_sub_f32 v173, v173, v181
    v_sub_f32 v174, v174, v181
    v_sub_f32 v175, v175, v181
    v_sub_f32 v176, v176, v181
    v_sub_f32 v177, v177, v181
    v_sub_f32 v178, v178, v181
    v_sub_f32 v179, v179, v181
    v_exp_f32 v164, v164
    v_exp_f32 v165, v165
    v_exp_f32 v166, v166
    v_exp_f32 v167, v167
    v_exp_f32 v168, v168
    v_exp_f32 v169, v169
    v_exp_f32 v170, v170
    v_exp_f32 v171, v171
    v_exp_f32 v172, v172
    v_exp_f32 v173, v173
    v_exp_f32 v174, v174
    v_exp_f32 v175, v175
    v_exp_f32 v176, v176
    v_exp_f32 v177, v177
    v_exp_f32 v178, v178
    v_exp_f32 v179, v179
    v_mul_f32 v68, v68, v182
    v_mul_f32 v69, v69, v182
    v_mul_f32 v70, v70, v182
    v_mul_f32 v71, v71, v182
    v_mul_f32 v72, v72, v182
    v_mul_f32 v73, v73, v182
    v_mul_f32 v74, v74, v182
    v_mul_f32 v75, v75, v182
    v_mul_f32 v76, v76, v182
    v_mul_f32 v77, v77, v182
    v_mul_f32 v78, v78, v182
    v_mul_f32 v79, v79, v182
    v_mul_f32 v80, v80, v182
    v_mul_f32 v81, v81, v182
    v_mul_f32 v82, v82, v182
    v_mul_f32 v83, v83, v182
    v_mul_f32 v84, v84, v182
    v_mul_f32 v85, v85, v182
    v_mul_f32 v86, v86, v182
    v_mul_f32 v87, v87, v182
    v_mul_f32 v88, v88, v182
    v_mul_f32 v89, v89, v182
    v_mul_f32 v90, v90, v182
    v_mul_f32 v91, v91, v182
    v_mul_f32 v92, v92, v182
    v_mul_f32 v93, v93, v182
    v_mul_f32 v94, v94, v182
    v_mul_f32 v95, v95, v182
    v_mul_f32 v96, v96, v182
    v_mul_f32 v97, v97, v182
    v_mul_f32 v98, v98, v182
    v_mul_f32 v99, v99, v182
    s_nop 1
    v_smfmac_f32_32x32x32_bf16 v[68:83], v[224:227], v[164:171], v240
    v_smfmac_f32_32x32x32_bf16 v[84:99], v[232:235], v[164:171], v240
    v_smfmac_f32_32x32x32_bf16 v[68:83], v[228:231], v[172:179], v240
    v_smfmac_f32_32x32x32_bf16 v[84:99], v[236:239], v[172:179], v240
    s_nop 15
    s_nop 3
    s_add_u32 s100, s100, 6144
    s_add_u32 s99, s99, 1
    s_cmp_lt_u32 s99, 56
    s_cbranch_scc1 L_fb1
    s_cmp_eq_u32 s98, 1
    s_cbranch_scc0 L_fbn1
    s_lshl_b32 s89, s98, 1
    s_add_u32 s41, s48, s89
    s_add_u32 s34, s28, s41
    s_lshr_b32 s35, s34, 1
    s_and_b32 s36, s34, 1
    s_lshl_b32 s37, s24, 1
    s_add_u32 s36, s36, s37
    s_sub_u32 s37, s24, 28
    s_cmp_eq_u32 s27, 1
    s_cselect_b32 s35, s37, s35
    s_cselect_b32 s36, s34, s36
    s_mul_i32 s90, s36, 28
    s_add_u32 s90, s90, s35
    s_mul_i32 s91, s36, 896
    s_lshl_b32 s35, s35, 3
    s_add_u32 s91, s91, s35
    s_mul_i32 s91, s91, 192
    s_lshl_b32 s90, s90, 12
    s_add_u32 s90, s90, 19267584
    v_mov_b32 v167, s92
    v_mov_b32 v171, s92
    v_mov_b32 v175, s92
    v_mov_b32 v179, s92
    v_mov_b32 v250, v92
    s_nop 1
    v_permlane32_swap_b32 v92, v250
    s_nop 1
    v_rcp_f32 v248, v92
    s_nop 0
    v_pk_mul_f32 v[68:69], v[68:69], v[248:249] op_sel_hi:[1,0]
    v_pk_mul_f32 v[70:71], v[70:71], v[248:249] op_sel_hi:[1,0]
    v_pk_mul_f32 v[72:73], v[72:73], v[248:249] op_sel_hi:[1,0]
    v_pk_mul_f32 v[74:75], v[74:75], v[248:249] op_sel_hi:[1,0]
    v_pk_mul_f32 v[76:77], v[76:77], v[248:249] op_sel_hi:[1,0]
    v_pk_mul_f32 v[78:79], v[78:79], v[248:249] op_sel_hi:[1,0]
    v_pk_mul_f32 v[80:81], v[80:81], v[248:249] op_sel_hi:[1,0]
    v_pk_mul_f32 v[82:83], v[82:83], v[248:249] op_sel_hi:[1,0]
    v_pk_mul_f32 v[84:85], v[84:85], v[248:249] op_sel_hi:[1,0]
    v_pk_mul_f32 v[86:87], v[86:87], v[248:249] op_sel_hi:[1,0]
    v_pk_mul_f32 v[88:89], v[88:89], v[248:249] op_sel_hi:[1,0]
    v_pk_mul_f32 v[90:91], v[90:91], v[248:249] op_sel_hi:[1,0]
    v_cvt_pk_bf16_f32 v164, v68, v69
    v_cvt_pk_bf16_f32 v165, v70, v71
    v_cvt_pk_bf16_f32 v166, v72, v73
    v_cvt_pk_bf16_f32 v168, v74, v75
    v_cvt_pk_bf16_f32 v169, v76, v77
    v_cvt_pk_bf16_f32 v170, v78, v79
    v_cvt_pk_bf16_f32 v172, v80, v81
    v_cvt_pk_bf16_f32 v173, v82, v83
    v_cvt_pk_bf16_f32 v174, v84, v85
    v_cvt_pk_bf16_f32 v176, v86, v87
    v_cvt_pk_bf16_f32 v177, v88, v89
    v_cvt_pk_bf16_f32 v178, v90, v91
    buffer_store_dwordx4 v[164:167], v254, s[20:23], s90 offen offset:0 sc1
    buffer_store_dwordx4 v[168:171], v254, s[20:23], s90 offen offset:1024 sc1
    buffer_store_dwordx4 v[172:175], v254, s[20:23], s90 offen offset:2048 sc1
    buffer_store_dwordx4 v[176:179], v254, s[20:23], s90 offen offset:3072 sc1
L_fbn1:
    s_bitcmp1_b32 s96, 2
    s_cbranch_scc0 L_fbn2
    v_mov_b32 v100, 0
    v_mov_b32 v101, 0
    v_mov_b32 v102, 0
    v_mov_b32 v103, 0
    v_mov_b32 v104, 0
    v_mov_b32 v105, 0
    v_mov_b32 v106, 0
    v_mov_b32 v107, 0
    v_mov_b32 v108, 0
    v_mov_b32 v109, 0
    v_mov_b32 v110, 0
    v_mov_b32 v111, 0
    v_mov_b32 v112, 0
    v_mov_b32 v113, 0
    v_mov_b32 v114, 0
    v_mov_b32 v115, 0
    v_mov_b32 v116, 0
    v_mov_b32 v117, 0
    v_mov_b32 v118, 0
    v_mov_b32 v119, 0
    v_mov_b32 v120, 0
    v_mov_b32 v121, 0
    v_mov_b32 v122, 0
    v_mov_b32 v123, 0
    v_mov_b32 v124, 0
    v_mov_b32 v125, 0
    v_mov_b32 v126, 0
    v_mov_b32 v127, 0
    v_mov_b32 v128, 0
    v_mov_b32 v129, 0
    v_mov_b32 v130, 0
    v_mov_b32 v131, 0
    v_mov_b32 v180, 0xff7fffff
    v_and_b32 v248, 31, v247
    v_cmp_eq_u32 vcc, 16, v248
    v_mov_b32 v249, 0x3f803f80
    s_nop 1
    v_cndmask_b32 v232, 0, v249, vcc
    v_cndmask_b32 v233, 0, v249, vcc
    v_cndmask_b32 v234, 0, v249, vcc
    v_cndmask_b32 v235, 0, v249, vcc
    v_cndmask_b32 v236, 0, v249, vcc
    v_cndmask_b32 v237, 0, v249, vcc
    v_cndmask_b32 v238, 0, v249, vcc
    v_cndmask_b32 v239, 0, v249, vcc
    v_lshrrev_b32 v183, 5, v247
    v_lshlrev_b32 v183, 8, v183
    v_and_b32 v184, 15, v247
    v_lshlrev_b32 v184, 4, v184
    v_add_u32 v183, v183, v184
    s_mov_b32 s99, 0
    s_mov_b32 s100, s40
L_fb2:
    s_add_u32 s101, s100, 4096
    buffer_load_dwordx4 v[212:215], v254, s[20:23], s100 offen offset:0 sc1
    buffer_load_dwordx4 v[216:219], v254, s[20:23], s100 offen offset:1024 sc1
    buffer_load_dwordx4 v[220:223], v254, s[20:23], s100 offen offset:2048 sc1
    buffer_load_dwordx4 v[224:227], v254, s[20:23], s100 offen offset:3072 sc1
    buffer_load_dwordx4 v[228:231], v254, s[20:23], s101 offen sc1
    s_mov_b32 s6, 0x0000ffff
    s_mov_b32 s7, 0x0000ffff
    s_mov_b64 exec, s[6:7]
    buffer_load_dwordx4 v[232:235], v183, s[20:23], s101 offen offset:1024 sc1
    buffer_load_dwordx4 v[236:239], v183, s[20:23], s101 offen offset:1536 sc1
    s_mov_b64 exec, -1
    s_waitcnt vmcnt(0)
    v_mfma_f32_32x32x16_bf16 v[164:179], v[212:215], v[24:27], 0
    v_mfma_f32_32x32x16_bf16 v[164:179], v[216:219], v[28:31], v[164:179]
    v_mfma_f32_32x32x16_bf16 v[164:179], v[220:223], v[32:35], v[164:179]
    s_nop 15
    s_nop 3
    v_max3_f32 v181, v164, v165, v166
    v_max3_f32 v181, v181, v167, v168
    v_max3_f32 v181, v181, v169, v170
    v_max3_f32 v181, v181, v171, v172
    v_max3_f32 v181, v181, v173, v174
    v_max3_f32 v181, v181, v175, v176
    v_max3_f32 v181, v181, v177, v178
    v_max3_f32 v181, v181, v179, v180
    v_mov_b32 v182, v181
    s_nop 1
    v_permlane32_swap_b32 v181, v182
    s_nop 1
    v_max_f32 v181, v181, v182
    v_sub_f32 v182, v180, v181
    v_exp_f32 v182, v182
    v_mov_b32 v180, v181
    v_sub_f32 v164, v164, v181
    v_sub_f32 v165, v165, v181
    v_sub_f32 v166, v166, v181
    v_sub_f32 v167, v167, v181
    v_sub_f32 v168, v168, v181
    v_sub_f32 v169, v169, v181
    v_sub_f32 v170, v170, v181
    v_sub_f32 v171, v171, v181
    v_sub_f32 v172, v172, v181
    v_sub_f32 v173, v173, v181
    v_sub_f32 v174, v174, v181
    v_sub_f32 v175, v175, v181
    v_sub_f32 v176, v176, v181
    v_sub_f32 v177, v177, v181
    v_sub_f32 v178, v178, v181
    v_sub_f32 v179, v179, v181
    v_exp_f32 v164, v164
    v_exp_f32 v165, v165
    v_exp_f32 v166, v166
    v_exp_f32 v167, v167
    v_exp_f32 v168, v168
    v_exp_f32 v169, v169
    v_exp_f32 v170, v170
    v_exp_f32 v171, v171
    v_exp_f32 v172, v172
    v_exp_f32 v173, v173
    v_exp_f32 v174, v174
    v_exp_f32 v175, v175
    v_exp_f32 v176, v176
    v_exp_f32 v177, v177
    v_exp_f32 v178, v178
    v_exp_f32 v179, v179
    v_mul_f32 v100, v100, v182
    v_mul_f32 v101, v101, v182
    v_mul_f32 v102, v102, v182
    v_mul_f32 v103, v103, v182
    v_mul_f32 v104, v104, v182
    v_mul_f32 v105, v105, v182
    v_mul_f32 v106, v106, v182
    v_mul_f32 v107, v107, v182
    v_mul_f32 v108, v108, v182
    v_mul_f32 v109, v109, v182
    v_mul_f32 v110, v110, v182
    v_mul_f32 v111, v111, v182
    v_mul_f32 v112, v112, v182
    v_mul_f32 v113, v113, v182
    v_mul_f32 v114, v114, v182
    v_mul_f32 v115, v115, v182
    v_mul_f32 v116, v116, v182
    v_mul_f32 v117, v117, v182
    v_mul_f32 v118, v118, v182
    v_mul_f32 v119, v119, v182
    v_mul_f32 v120, v120, v182
    v_mul_f32 v121, v121, v182
    v_mul_f32 v122, v122, v182
    v_mul_f32 v123, v123, v182
    v_mul_f32 v124, v124, v182
    v_mul_f32 v125, v125, v182
    v_mul_f32 v126, v126, v182
    v_mul_f32 v127, v127, v182
    v_mul_f32 v128, v128, v182
    v_mul_f32 v129, v129, v182
    v_mul_f32 v130, v130, v182
    v_mul_f32 v131, v131, v182
    s_nop 1
    v_smfmac_f32_32x32x32_bf16 v[100:115], v[224:227], v[164:171], v240
    v_smfmac_f32_32x32x32_bf16 v[116:131], v[232:235], v[164:171], v240
    v_smfmac_f32_32x32x32_bf16 v[100:115], v[228:231], v[172:179], v240
    v_smfmac_f32_32x32x32_bf16 v[116:131], v[236:239], v[172:179], v240
    s_nop 15
    s_nop 3
    s_add_u32 s100, s100, 6144
    s_add_u32 s99, s99, 1
    s_cmp_lt_u32 s99, 56
    s_cbranch_scc1 L_fb2
L_fbn2:
    s_waitcnt vmcnt(0)
    s_branch L_fb_retA
L_done:
L_end:
    s_endpgm
.section .rodata,"a"
.p2align 6
.amdhsa_kernel standalone__window_attn_cswin__vision_kernel
.amdhsa_next_free_vgpr 256
.amdhsa_next_free_sgpr 102
.amdhsa_accum_offset 256
.amdhsa_group_segment_fixed_size 0
.amdhsa_kernarg_size 48
.amdhsa_user_sgpr_count 2
.amdhsa_user_sgpr_kernarg_segment_ptr 1
.amdhsa_system_sgpr_workgroup_id_x 1
.end_amdhsa_kernel
.text
```
